```python
import torch

def _softmax(x, axis=-1):
    return torch.softmax(x, dim=axis)
def _gelu(x):
    return torch.nn.functional.gelu(x, approximate="tanh")
def _silu(x):
    return torch.nn.functional.silu(x)
def _sigmoid(x):
    return torch.sigmoid(x)
def _layernorm(x, axis=-1, eps=1e-5):
    m = x.mean(dim=axis, keepdim=True)
    v = x.var(dim=axis, keepdim=True, unbiased=False)
    return (x - m) / torch.sqrt(v + eps)
def _scatter_add(tgt, idx, src, axis=0):
    return tgt.clone().index_add_(axis, idx, src)
def _segment_sum(src, seg, n):
    out = torch.zeros((n,) + src.shape[1:], dtype=src.dtype)
    return out.index_add_(0, seg, src)
def _pad(x, pw):
    flat = tuple(v for pair in reversed(pw) for v in pair)
    return torch.nn.functional.pad(x, flat)

kernel_name = 'sequential_preLN__mha_block_cached__swiglu_ffn__decode'

def setup_inputs():

    _w = (lambda a: (lambda t: t.to(torch.bfloat16) if t.is_floating_point() else t)(torch.as_tensor(a)))
    def _A_setup():
        B, Sq, D = 1, 1, 640
        H, Sk, Dh = 32, 16384, 128
        return {
            "x": _w((lambda *s: torch.randn(*s, dtype=torch.bfloat16) * 0.05)(B, Sq, D)),
            "k_cache": _w((lambda *s: torch.randn(*s, dtype=torch.bfloat16) * 3.2)(B, H, Sk, Dh)),
            "v_cache": _w((lambda *s: torch.randn(*s, dtype=torch.bfloat16) * 0.4)(B, H, Sk, Dh)),
            "wq": _w((lambda *s: torch.randn(*s, dtype=torch.bfloat16) * 3.2)(D, H * Dh) * (D ** -0.5)),
            "wo": _w((lambda *s: torch.randn(*s, dtype=torch.bfloat16) * 0.4)(H * Dh, D) * ((H * Dh) ** -0.5)),
        }
    _A_in = _A_setup()

    def _B_setup():
        B, S, D, F = 1, 1, 640, 1728
        return {
            "x": _w((lambda *s: torch.randn(*s, dtype=torch.bfloat16) * 0.05)(B, S, D)),
            "w_gate": _w((lambda *s: torch.randn(*s, dtype=torch.bfloat16) * 0.05)(D, F)),
            "w_up": _w((lambda *s: torch.randn(*s, dtype=torch.bfloat16) * 0.05)(D, F)),
            "w_down": _w((lambda *s: torch.randn(*s, dtype=torch.bfloat16) * 0.05)(F, D)),
        }
    _B_in = _B_setup()

    return {
        "A_x": _A_in["x"],
        "A_k_cache": _A_in["k_cache"],
        "A_v_cache": _A_in["v_cache"],
        "A_wq": _A_in["wq"],
        "A_wo": _A_in["wo"],
        "B_x": _B_in["x"],
        "B_w_gate": _B_in["w_gate"],
        "B_w_up": _B_in["w_up"],
        "B_w_down": _B_in["w_down"],
    }

def reference(A_x, A_k_cache, A_v_cache, A_wq, A_wo, B_x, B_w_gate, B_w_up, B_w_down):
    def _A_ref(x, k_cache, v_cache, wq, wo):
        B, Sq, D = x.shape
        H, Dh = 32, 128
        q = (lambda x, *d: x.permute(*d))((x @ wq).reshape(B, Sq, H, Dh), 0, 2, 1, 3)
        scores = torch.einsum("bhqd,bhkd->bhqk", q, k_cache) * (Dh ** -0.5)
        p = _softmax(scores, axis=-1)
        o = torch.einsum("bhqk,bhkd->bhqd", p, v_cache)
        return (lambda x, *d: x.permute(*d))(o, 0, 2, 1, 3).reshape(B, Sq, H * Dh) @ wo

    def _B_ref(x, w_gate, w_up, w_down):
        g = _silu(x @ w_gate)
        u = x @ w_up
        return (g * u) @ w_down

    x = A_x
    h = x + _A_ref(_layernorm(x, axis=-1), A_k_cache, A_v_cache, A_wq, A_wo)
    h2 = h + _B_ref(_layernorm(h, axis=-1), B_w_gate, B_w_up, B_w_down)
    return h2
```

```asm
; @launch grid=(256,1,1) block=(768,1,1) lds=62336
.amdgcn_target "amdgcn-amd-amdhsa--gfx950"
.text
.globl sequential_preLN__mha_block_cached__swiglu_ffn__decode_kernel
.p2align 8
.type sequential_preLN__mha_block_cached__swiglu_ffn__decode_kernel,@function
sequential_preLN__mha_block_cached__swiglu_ffn__decode_kernel:
  s_cmp_ge_u32 s2, 256
  s_cbranch_scc1 L_exit
  s_load_dwordx16 s[16:31], s[0:1], 0
  s_load_dwordx8 s[32:39], s[0:1], 64
  v_lshrrev_b32 v1, 6, v0
  v_and_b32 v0, 63, v0
  v_readfirstlane_b32 s3, v1
  v_lshlrev_b32 v1, 4, v0
  s_and_b32 s4, s2, 7
  s_lshl_b32 s4, s4, 5
  s_lshr_b32 s2, s2, 3
  s_or_b32 s2, s2, s4
  s_lshr_b32 s4, s2, 4
  s_and_b32 s67, s2, 15
  s_lshl_b32 s67, s67, 4
  s_add_u32 s67, s67, s4
  s_cmp_ge_u32 s3, 4
  s_cbranch_scc1 L_helper
  s_and_b32 s5, s2, 15
  s_lshr_b32 s13, s4, 1
  s_and_b32 s14, s13, 4
  s_add_u32 s13, s13, s14
  s_and_b32 s14, s4, 1
  s_lshl_b32 s14, s14, 2
  s_or_b32 s13, s13, s14
  s_lshl_b32 s13, s13, 22
  s_and_b32 s14, s5, 1
  s_lshl_b32 s14, s14, 16
  s_add_u32 s13, s13, s14
  s_and_b32 s14, s5, 2
  s_lshl_b32 s14, s14, 17
  s_add_u32 s13, s13, s14
  s_and_b32 s14, s5, 4
  s_lshl_b32 s14, s14, 17
  s_add_u32 s13, s13, s14
  s_and_b32 s14, s5, 8
  s_lshl_b32 s14, s14, 18
  s_add_u32 s13, s13, s14
  s_and_b32 s14, s3, 1
  s_lshl_b32 s14, s14, 12
  s_add_u32 s13, s13, s14
  s_and_b32 s14, s3, 2
  s_lshl_b32 s14, s14, 12
  s_add_u32 s13, s13, s14
  s_mov_b32 s12, 0
  s_mov_b32 s42, 0
  s_lshl_b32 s14, s3, 12
  s_mov_b32 s10, 0x12d000
  s_mov_b32 s11, 0x20000
  s_waitcnt lgkmcnt(0)
  s_add_u32 s8, s18, s13
  s_addc_u32 s9, s19, 0
  buffer_load_dwordx4 v[36:39], v1, s[8:11], s12 offen offset:0 nt
  buffer_load_dwordx4 v[40:43], v1, s[8:11], s12 offen offset:1024 nt
  buffer_load_dwordx4 v[44:47], v1, s[8:11], s12 offen offset:2048 nt
  buffer_load_dwordx4 v[48:51], v1, s[8:11], s12 offen offset:3072 nt
  s_xor_b32 s12, s42, 0x8000
  buffer_load_dwordx4 v[52:55], v1, s[8:11], s12 offen offset:0 nt
  buffer_load_dwordx4 v[56:59], v1, s[8:11], s12 offen offset:1024 nt
  s_add_u32 s14, s14, 2048
  v_lshlrev_b32 v20, 2, v0
  v_add_u32 v20, s14, v20
  v_and_b32 v21, 15, v0
  v_lshlrev_b32 v21, 4, v21
  v_mov_b32 v22, 0
  v_mov_b32 v23, 1
  v_mov_b32 v3, 0
  s_barrier
  s_sub_u32 s15, s67, 160
  s_cmp_lt_u32 s15, 54
  s_cselect_b32 s15, 2, 1
  s_waitcnt vmcnt(5)
  buffer_load_dwordx4 v[60:63], v1, s[8:11], s12 offen offset:2048 nt
  s_waitcnt vmcnt(5)
  buffer_load_dwordx4 v[64:67], v1, s[8:11], s12 offen offset:3072 nt
  s_xor_b32 s12, s42, 0x4000
  s_waitcnt vmcnt(5)
  buffer_load_dwordx4 v[68:71], v1, s[8:11], s12 offen offset:0 nt
  s_waitcnt vmcnt(5)
  buffer_load_dwordx4 v[72:75], v1, s[8:11], s12 offen offset:1024 nt
  s_waitcnt vmcnt(5)
  buffer_load_dwordx4 v[76:79], v1, s[8:11], s12 offen offset:2048 nt
  s_waitcnt vmcnt(5)
  buffer_load_dwordx4 v[80:83], v1, s[8:11], s12 offen offset:3072 nt
  s_xor_b32 s12, s42, 0xc000
  s_waitcnt vmcnt(5)
  buffer_load_dwordx4 v[84:87], v1, s[8:11], s12 offen offset:0 nt
  s_waitcnt vmcnt(5)
  buffer_load_dwordx4 v[88:91], v1, s[8:11], s12 offen offset:1024 nt
  s_waitcnt vmcnt(5)
  buffer_load_dwordx4 v[92:95], v1, s[8:11], s12 offen offset:2048 nt
  s_waitcnt vmcnt(5)
  buffer_load_dwordx4 v[96:99], v1, s[8:11], s12 offen offset:3072 nt
  s_add_u32 s42, s42, 0xe0000
  s_and_b32 s42, s42, 0x120000
  s_xor_b32 s12, s42, 0x0
  s_waitcnt vmcnt(5)
  buffer_load_dwordx4 v[100:103], v1, s[8:11], s12 offen offset:0 nt
  s_waitcnt vmcnt(5)
  buffer_load_dwordx4 v[104:107], v1, s[8:11], s12 offen offset:1024 nt
  s_waitcnt vmcnt(5)
  buffer_load_dwordx4 v[108:111], v1, s[8:11], s12 offen offset:2048 nt
  s_waitcnt vmcnt(5)
  buffer_load_dwordx4 v[112:115], v1, s[8:11], s12 offen offset:3072 nt
  s_xor_b32 s12, s42, 0x8000
  s_waitcnt vmcnt(5)
  buffer_load_dwordx4 v[116:119], v1, s[8:11], s12 offen offset:0 nt
  s_waitcnt vmcnt(5)
  buffer_load_dwordx4 v[120:123], v1, s[8:11], s12 offen offset:1024 nt
  s_waitcnt vmcnt(5)
  buffer_load_dwordx4 v[124:127], v1, s[8:11], s12 offen offset:2048 nt
  s_waitcnt vmcnt(5)
  buffer_load_dwordx4 v[128:131], v1, s[8:11], s12 offen offset:3072 nt
  s_xor_b32 s12, s42, 0x4000
  s_waitcnt vmcnt(5)
  buffer_load_dwordx4 v[132:135], v1, s[8:11], s12 offen offset:0 nt
  s_waitcnt vmcnt(5)
  buffer_load_dwordx4 v[136:139], v1, s[8:11], s12 offen offset:1024 nt
  s_waitcnt vmcnt(5)
  buffer_load_dwordx4 v[140:143], v1, s[8:11], s12 offen offset:2048 nt
  s_waitcnt vmcnt(5)
  buffer_load_dwordx4 v[144:147], v1, s[8:11], s12 offen offset:3072 nt
  s_xor_b32 s12, s42, 0xc000
  s_mov_b32 s60, 4000000
L_lw_1:
  ds_read_b32 v8, v22 offset:4
  s_waitcnt lgkmcnt(0)
  v_cmp_gt_u32 vcc, 4, v8
  s_cbranch_vccz L_lwd_2
  s_sleep 1
  s_sub_u32 s60, s60, 1
  s_cbranch_scc0 L_lw_1
L_lwd_2:
  ds_read_b128 v[4:7], v21 offset:256
  ds_read_b128 v[16:19], v21 offset:512
  s_waitcnt lgkmcnt(0)
  s_waitcnt vmcnt(5)
  buffer_load_dwordx4 v[148:151], v1, s[8:11], s12 offen offset:0 nt
  s_waitcnt vmcnt(5)
  buffer_load_dwordx4 v[152:155], v1, s[8:11], s12 offen offset:1024 nt
  s_waitcnt vmcnt(5)
  buffer_load_dwordx4 v[156:159], v1, s[8:11], s12 offen offset:2048 nt
  s_waitcnt vmcnt(5)
  buffer_load_dwordx4 v[160:163], v1, s[8:11], s12 offen offset:3072 nt
  s_add_u32 s42, s42, 0xe0000
  s_and_b32 s42, s42, 0x120000
  s_xor_b32 s12, s42, 0x0
  s_mov_b64 exec, 1
  ds_add_u32 v3, v23 offset:44
  s_mov_b64 exec, -1
  v_dot2_f32_bf16 v8, v36, v4, 0
  v_dot2_f32_bf16 v9, v40, v4, 0
  v_dot2_f32_bf16 v10, v44, v4, 0
  v_dot2_f32_bf16 v11, v48, v4, 0
  v_dot2_f32_bf16 v8, v37, v5, v8
  v_dot2_f32_bf16 v9, v41, v5, v9
  v_dot2_f32_bf16 v10, v45, v5, v10
  v_dot2_f32_bf16 v11, v49, v5, v11
  v_dot2_f32_bf16 v8, v38, v6, v8
  v_dot2_f32_bf16 v9, v42, v6, v9
  v_dot2_f32_bf16 v10, v46, v6, v10
  v_dot2_f32_bf16 v11, v50, v6, v11
  v_dot2_f32_bf16 v8, v39, v7, v8
  v_dot2_f32_bf16 v9, v43, v7, v9
  v_dot2_f32_bf16 v10, v47, v7, v10
  v_dot2_f32_bf16 v11, v51, v7, v11
  v_add_f32_dpp v12, v8, v8 row_ror:8 row_mask:0xf bank_mask:0x3
  s_nop 0
  v_add_f32_dpp v13, v10, v10 row_ror:8 row_mask:0xf bank_mask:0x3
  v_add_f32_dpp v12, v9, v9 row_ror:8 row_mask:0xf bank_mask:0xc
  s_nop 0
  v_add_f32_dpp v13, v11, v11 row_ror:8 row_mask:0xf bank_mask:0xc
  v_add_f32_dpp v14, v12, v12 row_half_mirror row_mask:0xf bank_mask:0x5
  s_nop 1
  v_add_f32_dpp v14, v13, v13 row_half_mirror row_mask:0xf bank_mask:0xa
  ds_write_b32 v20, v14 offset:0
  v_dot2_f32_bf16 v8, v52, v4, 0
  v_dot2_f32_bf16 v9, v56, v4, 0
  v_dot2_f32_bf16 v10, v60, v4, 0
  v_dot2_f32_bf16 v11, v64, v4, 0
  v_dot2_f32_bf16 v8, v53, v5, v8
  v_dot2_f32_bf16 v9, v57, v5, v9
  v_dot2_f32_bf16 v10, v61, v5, v10
  v_dot2_f32_bf16 v11, v65, v5, v11
  v_dot2_f32_bf16 v8, v54, v6, v8
  v_dot2_f32_bf16 v9, v58, v6, v9
  v_dot2_f32_bf16 v10, v62, v6, v10
  v_dot2_f32_bf16 v11, v66, v6, v11
  v_dot2_f32_bf16 v8, v55, v7, v8
  v_dot2_f32_bf16 v9, v59, v7, v9
  v_dot2_f32_bf16 v10, v63, v7, v10
  v_dot2_f32_bf16 v11, v67, v7, v11
  v_add_f32_dpp v12, v8, v8 row_ror:8 row_mask:0xf bank_mask:0x3
  s_nop 0
  v_add_f32_dpp v13, v10, v10 row_ror:8 row_mask:0xf bank_mask:0x3
  v_add_f32_dpp v12, v9, v9 row_ror:8 row_mask:0xf bank_mask:0xc
  s_nop 0
  v_add_f32_dpp v13, v11, v11 row_ror:8 row_mask:0xf bank_mask:0xc
  v_add_f32_dpp v14, v12, v12 row_half_mirror row_mask:0xf bank_mask:0x5
  s_nop 1
  v_add_f32_dpp v14, v13, v13 row_half_mirror row_mask:0xf bank_mask:0xa
  ds_write_b32 v20, v14 offset:256
  s_waitcnt vmcnt(5)
  buffer_load_dwordx4 v[36:39], v1, s[8:11], s12 offen offset:0 nt
  s_waitcnt vmcnt(5)
  buffer_load_dwordx4 v[40:43], v1, s[8:11], s12 offen offset:1024 nt
  s_waitcnt vmcnt(5)
  buffer_load_dwordx4 v[44:47], v1, s[8:11], s12 offen offset:2048 nt
  s_waitcnt vmcnt(5)
  buffer_load_dwordx4 v[48:51], v1, s[8:11], s12 offen offset:3072 nt
  s_xor_b32 s12, s42, 0x8000
  s_mov_b64 exec, 1
  ds_add_u32 v3, v23 offset:44
  s_mov_b64 exec, -1
  v_dot2_f32_bf16 v8, v68, v4, 0
  v_dot2_f32_bf16 v9, v72, v4, 0
  v_dot2_f32_bf16 v10, v76, v4, 0
  v_dot2_f32_bf16 v11, v80, v4, 0
  v_dot2_f32_bf16 v8, v69, v5, v8
  v_dot2_f32_bf16 v9, v73, v5, v9
  v_dot2_f32_bf16 v10, v77, v5, v10
  v_dot2_f32_bf16 v11, v81, v5, v11
  v_dot2_f32_bf16 v8, v70, v6, v8
  v_dot2_f32_bf16 v9, v74, v6, v9
  v_dot2_f32_bf16 v10, v78, v6, v10
  v_dot2_f32_bf16 v11, v82, v6, v11
  v_dot2_f32_bf16 v8, v71, v7, v8
  v_dot2_f32_bf16 v9, v75, v7, v9
  v_dot2_f32_bf16 v10, v79, v7, v10
  v_dot2_f32_bf16 v11, v83, v7, v11
  v_add_f32_dpp v12, v8, v8 row_ror:8 row_mask:0xf bank_mask:0x3
  s_nop 0
  v_add_f32_dpp v13, v10, v10 row_ror:8 row_mask:0xf bank_mask:0x3
  v_add_f32_dpp v12, v9, v9 row_ror:8 row_mask:0xf bank_mask:0xc
  s_nop 0
  v_add_f32_dpp v13, v11, v11 row_ror:8 row_mask:0xf bank_mask:0xc
  v_add_f32_dpp v14, v12, v12 row_half_mirror row_mask:0xf bank_mask:0x5
  s_nop 1
  v_add_f32_dpp v14, v13, v13 row_half_mirror row_mask:0xf bank_mask:0xa
  ds_write_b32 v20, v14 offset:512
  v_dot2_f32_bf16 v8, v84, v4, 0
  v_dot2_f32_bf16 v9, v88, v4, 0
  v_dot2_f32_bf16 v10, v92, v4, 0
  v_dot2_f32_bf16 v11, v96, v4, 0
  v_dot2_f32_bf16 v8, v85, v5, v8
  v_dot2_f32_bf16 v9, v89, v5, v9
  v_dot2_f32_bf16 v10, v93, v5, v10
  v_dot2_f32_bf16 v11, v97, v5, v11
  v_dot2_f32_bf16 v8, v86, v6, v8
  v_dot2_f32_bf16 v9, v90, v6, v9
  v_dot2_f32_bf16 v10, v94, v6, v10
  v_dot2_f32_bf16 v11, v98, v6, v11
  v_dot2_f32_bf16 v8, v87, v7, v8
  v_dot2_f32_bf16 v9, v91, v7, v9
  v_dot2_f32_bf16 v10, v95, v7, v10
  v_dot2_f32_bf16 v11, v99, v7, v11
  v_add_f32_dpp v12, v8, v8 row_ror:8 row_mask:0xf bank_mask:0x3
  s_nop 0
  v_add_f32_dpp v13, v10, v10 row_ror:8 row_mask:0xf bank_mask:0x3
  v_add_f32_dpp v12, v9, v9 row_ror:8 row_mask:0xf bank_mask:0xc
  s_nop 0
  v_add_f32_dpp v13, v11, v11 row_ror:8 row_mask:0xf bank_mask:0xc
  v_add_f32_dpp v14, v12, v12 row_half_mirror row_mask:0xf bank_mask:0x5
  s_nop 1
  v_add_f32_dpp v14, v13, v13 row_half_mirror row_mask:0xf bank_mask:0xa
  ds_write_b32 v20, v14 offset:768
  v_dot2_f32_bf16 v8, v100, v4, 0
  v_dot2_f32_bf16 v9, v104, v4, 0
  v_dot2_f32_bf16 v10, v108, v4, 0
  v_dot2_f32_bf16 v11, v112, v4, 0
  v_dot2_f32_bf16 v8, v101, v5, v8
  v_dot2_f32_bf16 v9, v105, v5, v9
  v_dot2_f32_bf16 v10, v109, v5, v10
  v_dot2_f32_bf16 v11, v113, v5, v11
  v_dot2_f32_bf16 v8, v102, v6, v8
  v_dot2_f32_bf16 v9, v106, v6, v9
  v_dot2_f32_bf16 v10, v110, v6, v10
  v_dot2_f32_bf16 v11, v114, v6, v11
  v_dot2_f32_bf16 v8, v103, v7, v8
  v_dot2_f32_bf16 v9, v107, v7, v9
  v_dot2_f32_bf16 v10, v111, v7, v10
  v_dot2_f32_bf16 v11, v115, v7, v11
  v_add_f32_dpp v12, v8, v8 row_ror:8 row_mask:0xf bank_mask:0x3
  s_nop 0
  v_add_f32_dpp v13, v10, v10 row_ror:8 row_mask:0xf bank_mask:0x3
  v_add_f32_dpp v12, v9, v9 row_ror:8 row_mask:0xf bank_mask:0xc
  s_nop 0
  v_add_f32_dpp v13, v11, v11 row_ror:8 row_mask:0xf bank_mask:0xc
  v_add_f32_dpp v14, v12, v12 row_half_mirror row_mask:0xf bank_mask:0x5
  s_nop 1
  v_add_f32_dpp v14, v13, v13 row_half_mirror row_mask:0xf bank_mask:0xa
  ds_write_b32 v20, v14 offset:1024
  v_dot2_f32_bf16 v8, v116, v4, 0
  v_dot2_f32_bf16 v9, v120, v4, 0
  v_dot2_f32_bf16 v10, v124, v4, 0
  v_dot2_f32_bf16 v11, v128, v4, 0
  v_dot2_f32_bf16 v8, v117, v5, v8
  v_dot2_f32_bf16 v9, v121, v5, v9
  v_dot2_f32_bf16 v10, v125, v5, v10
  v_dot2_f32_bf16 v11, v129, v5, v11
  v_dot2_f32_bf16 v8, v118, v6, v8
  v_dot2_f32_bf16 v9, v122, v6, v9
  v_dot2_f32_bf16 v10, v126, v6, v10
  v_dot2_f32_bf16 v11, v130, v6, v11
  v_dot2_f32_bf16 v8, v119, v7, v8
  v_dot2_f32_bf16 v9, v123, v7, v9
  v_dot2_f32_bf16 v10, v127, v7, v10
  v_dot2_f32_bf16 v11, v131, v7, v11
  v_add_f32_dpp v12, v8, v8 row_ror:8 row_mask:0xf bank_mask:0x3
  s_nop 0
  v_add_f32_dpp v13, v10, v10 row_ror:8 row_mask:0xf bank_mask:0x3
  v_add_f32_dpp v12, v9, v9 row_ror:8 row_mask:0xf bank_mask:0xc
  s_nop 0
  v_add_f32_dpp v13, v11, v11 row_ror:8 row_mask:0xf bank_mask:0xc
  v_add_f32_dpp v14, v12, v12 row_half_mirror row_mask:0xf bank_mask:0x5
  s_nop 1
  v_add_f32_dpp v14, v13, v13 row_half_mirror row_mask:0xf bank_mask:0xa
  ds_write_b32 v20, v14 offset:1280
  s_waitcnt vmcnt(5)
  buffer_load_dwordx4 v[52:55], v1, s[8:11], s12 offen offset:0 nt
  s_waitcnt vmcnt(5)
  buffer_load_dwordx4 v[56:59], v1, s[8:11], s12 offen offset:1024 nt
  s_waitcnt vmcnt(5)
  buffer_load_dwordx4 v[60:63], v1, s[8:11], s12 offen offset:2048 nt
  s_waitcnt vmcnt(5)
  buffer_load_dwordx4 v[64:67], v1, s[8:11], s12 offen offset:3072 nt
  s_xor_b32 s12, s42, 0x4000
  s_mov_b64 exec, 1
  ds_add_u32 v3, v23 offset:44
  s_mov_b64 exec, -1
  v_dot2_f32_bf16 v8, v132, v4, 0
  v_dot2_f32_bf16 v9, v136, v4, 0
  v_dot2_f32_bf16 v10, v140, v4, 0
  v_dot2_f32_bf16 v11, v144, v4, 0
  v_dot2_f32_bf16 v8, v133, v5, v8
  v_dot2_f32_bf16 v9, v137, v5, v9
  v_dot2_f32_bf16 v10, v141, v5, v10
  v_dot2_f32_bf16 v11, v145, v5, v11
  v_dot2_f32_bf16 v8, v134, v6, v8
  v_dot2_f32_bf16 v9, v138, v6, v9
  v_dot2_f32_bf16 v10, v142, v6, v10
  v_dot2_f32_bf16 v11, v146, v6, v11
  v_dot2_f32_bf16 v8, v135, v7, v8
  v_dot2_f32_bf16 v9, v139, v7, v9
  v_dot2_f32_bf16 v10, v143, v7, v10
  v_dot2_f32_bf16 v11, v147, v7, v11
  v_add_f32_dpp v12, v8, v8 row_ror:8 row_mask:0xf bank_mask:0x3
  s_nop 0
  v_add_f32_dpp v13, v10, v10 row_ror:8 row_mask:0xf bank_mask:0x3
  v_add_f32_dpp v12, v9, v9 row_ror:8 row_mask:0xf bank_mask:0xc
  s_nop 0
  v_add_f32_dpp v13, v11, v11 row_ror:8 row_mask:0xf bank_mask:0xc
  v_add_f32_dpp v14, v12, v12 row_half_mirror row_mask:0xf bank_mask:0x5
  s_nop 1
  v_add_f32_dpp v14, v13, v13 row_half_mirror row_mask:0xf bank_mask:0xa
  ds_write_b32 v20, v14 offset:1536
  v_dot2_f32_bf16 v8, v148, v4, 0
  v_dot2_f32_bf16 v9, v152, v4, 0
  v_dot2_f32_bf16 v10, v156, v4, 0
  v_dot2_f32_bf16 v11, v160, v4, 0
  v_dot2_f32_bf16 v8, v149, v5, v8
  v_dot2_f32_bf16 v9, v153, v5, v9
  v_dot2_f32_bf16 v10, v157, v5, v10
  v_dot2_f32_bf16 v11, v161, v5, v11
  v_dot2_f32_bf16 v8, v150, v6, v8
  v_dot2_f32_bf16 v9, v154, v6, v9
  v_dot2_f32_bf16 v10, v158, v6, v10
  v_dot2_f32_bf16 v11, v162, v6, v11
  v_dot2_f32_bf16 v8, v151, v7, v8
  v_dot2_f32_bf16 v9, v155, v7, v9
  v_dot2_f32_bf16 v10, v159, v7, v10
  v_dot2_f32_bf16 v11, v163, v7, v11
  v_add_f32_dpp v12, v8, v8 row_ror:8 row_mask:0xf bank_mask:0x3
  s_nop 0
  v_add_f32_dpp v13, v10, v10 row_ror:8 row_mask:0xf bank_mask:0x3
  v_add_f32_dpp v12, v9, v9 row_ror:8 row_mask:0xf bank_mask:0xc
  s_nop 0
  v_add_f32_dpp v13, v11, v11 row_ror:8 row_mask:0xf bank_mask:0xc
  v_add_f32_dpp v14, v12, v12 row_half_mirror row_mask:0xf bank_mask:0x5
  s_nop 1
  v_add_f32_dpp v14, v13, v13 row_half_mirror row_mask:0xf bank_mask:0xa
  ds_write_b32 v20, v14 offset:1792
  v_add_u32 v20, 0x800, v20
  s_add_u32 s40, s8, 0x4000000
  s_addc_u32 s41, s9, 0
  s_mov_b32 s43, 0x12d000
  s_mov_b32 s6, 2
  s_mov_b32 s7, 0
L_kiter:
  s_waitcnt vmcnt(6)
  s_cmp_ge_u32 s15, 2
  s_cbranch_scc1 L_go_3
  s_waitcnt vmcnt(5)
  s_cmp_ge_u32 s15, 1
  s_cbranch_scc1 L_go_3
  s_waitcnt vmcnt(4)
L_go_3:
  buffer_load_dwordx4 v[68:71], v1, s[8:11], s12 offen offset:0 nt
  s_waitcnt vmcnt(6)
  s_cmp_ge_u32 s15, 2
  s_cbranch_scc1 L_go_4
  s_waitcnt vmcnt(5)
  s_cmp_ge_u32 s15, 1
  s_cbranch_scc1 L_go_4
  s_waitcnt vmcnt(4)
L_go_4:
  buffer_load_dwordx4 v[72:75], v1, s[8:11], s12 offen offset:1024 nt
  s_waitcnt vmcnt(6)
  s_cmp_ge_u32 s15, 2
  s_cbranch_scc1 L_go_5
  s_waitcnt vmcnt(5)
  s_cmp_ge_u32 s15, 1
  s_cbranch_scc1 L_go_5
  s_waitcnt vmcnt(4)
L_go_5:
  buffer_load_dwordx4 v[76:79], v1, s[8:11], s12 offen offset:2048 nt
  s_waitcnt vmcnt(6)
  s_cmp_ge_u32 s15, 2
  s_cbranch_scc1 L_go_6
  s_waitcnt vmcnt(5)
  s_cmp_ge_u32 s15, 1
  s_cbranch_scc1 L_go_6
  s_waitcnt vmcnt(4)
L_go_6:
  buffer_load_dwordx4 v[80:83], v1, s[8:11], s12 offen offset:3072 nt
  s_xor_b32 s12, s42, 0xc000
  s_mov_b64 exec, 1
  ds_add_u32 v3, v23 offset:44
  s_mov_b64 exec, -1
  ds_read_b32 v2, v3 offset:28
  v_dot2_f32_bf16 v8, v36, v4, 0
  v_dot2_f32_bf16 v9, v40, v4, 0
  v_dot2_f32_bf16 v10, v44, v4, 0
  v_dot2_f32_bf16 v11, v48, v4, 0
  v_dot2_f32_bf16 v8, v37, v5, v8
  v_dot2_f32_bf16 v9, v41, v5, v9
  v_dot2_f32_bf16 v10, v45, v5, v10
  v_dot2_f32_bf16 v11, v49, v5, v11
  v_dot2_f32_bf16 v8, v38, v6, v8
  v_dot2_f32_bf16 v9, v42, v6, v9
  v_dot2_f32_bf16 v10, v46, v6, v10
  v_dot2_f32_bf16 v11, v50, v6, v11
  v_dot2_f32_bf16 v8, v39, v7, v8
  v_dot2_f32_bf16 v9, v43, v7, v9
  v_dot2_f32_bf16 v10, v47, v7, v10
  v_dot2_f32_bf16 v11, v51, v7, v11
  v_add_f32_dpp v12, v8, v8 row_ror:8 row_mask:0xf bank_mask:0x3
  s_nop 0
  v_add_f32_dpp v13, v10, v10 row_ror:8 row_mask:0xf bank_mask:0x3
  v_add_f32_dpp v12, v9, v9 row_ror:8 row_mask:0xf bank_mask:0xc
  s_nop 0
  v_add_f32_dpp v13, v11, v11 row_ror:8 row_mask:0xf bank_mask:0xc
  v_add_f32_dpp v14, v12, v12 row_half_mirror row_mask:0xf bank_mask:0x5
  s_nop 1
  v_add_f32_dpp v14, v13, v13 row_half_mirror row_mask:0xf bank_mask:0xa
  ds_write_b32 v20, v14 offset:0
  s_waitcnt lgkmcnt(0)
  v_readfirstlane_b32 s45, v2
  s_sub_u32 s45, s45, 1
  s_cselect_b32 s15, s15, s45
  s_waitcnt vmcnt(6)
  s_cmp_ge_u32 s15, 2
  s_cbranch_scc1 L_go_7
  s_waitcnt vmcnt(5)
  s_cmp_ge_u32 s15, 1
  s_cbranch_scc1 L_go_7
  s_waitcnt vmcnt(4)
L_go_7:
  buffer_load_dwordx4 v[84:87], v1, s[8:11], s12 offen offset:0 nt
  s_waitcnt vmcnt(6)
  s_cmp_ge_u32 s15, 2
  s_cbranch_scc1 L_go_8
  s_waitcnt vmcnt(5)
  s_cmp_ge_u32 s15, 1
  s_cbranch_scc1 L_go_8
  s_waitcnt vmcnt(4)
L_go_8:
  buffer_load_dwordx4 v[88:91], v1, s[8:11], s12 offen offset:1024 nt
  s_waitcnt vmcnt(6)
  s_cmp_ge_u32 s15, 2
  s_cbranch_scc1 L_go_9
  s_waitcnt vmcnt(5)
  s_cmp_ge_u32 s15, 1
  s_cbranch_scc1 L_go_9
  s_waitcnt vmcnt(4)
L_go_9:
  buffer_load_dwordx4 v[92:95], v1, s[8:11], s12 offen offset:2048 nt
  s_waitcnt vmcnt(6)
  s_cmp_ge_u32 s15, 2
  s_cbranch_scc1 L_go_10
  s_waitcnt vmcnt(5)
  s_cmp_ge_u32 s15, 1
  s_cbranch_scc1 L_go_10
  s_waitcnt vmcnt(4)
L_go_10:
  buffer_load_dwordx4 v[96:99], v1, s[8:11], s12 offen offset:3072 nt
  s_add_u32 s42, s42, 0xe0000
  s_and_b32 s42, s42, 0x120000
  s_xor_b32 s12, s42, 0x0
  s_mov_b64 exec, 1
  ds_add_u32 v3, v23 offset:44
  s_mov_b64 exec, -1
  v_dot2_f32_bf16 v8, v52, v4, 0
  v_dot2_f32_bf16 v9, v56, v4, 0
  v_dot2_f32_bf16 v10, v60, v4, 0
  v_dot2_f32_bf16 v11, v64, v4, 0
  v_dot2_f32_bf16 v8, v53, v5, v8
  v_dot2_f32_bf16 v9, v57, v5, v9
  v_dot2_f32_bf16 v10, v61, v5, v10
  v_dot2_f32_bf16 v11, v65, v5, v11
  v_dot2_f32_bf16 v8, v54, v6, v8
  v_dot2_f32_bf16 v9, v58, v6, v9
  v_dot2_f32_bf16 v10, v62, v6, v10
  v_dot2_f32_bf16 v11, v66, v6, v11
  v_dot2_f32_bf16 v8, v55, v7, v8
  v_dot2_f32_bf16 v9, v59, v7, v9
  v_dot2_f32_bf16 v10, v63, v7, v10
  v_dot2_f32_bf16 v11, v67, v7, v11
  v_add_f32_dpp v12, v8, v8 row_ror:8 row_mask:0xf bank_mask:0x3
  s_nop 0
  v_add_f32_dpp v13, v10, v10 row_ror:8 row_mask:0xf bank_mask:0x3
  v_add_f32_dpp v12, v9, v9 row_ror:8 row_mask:0xf bank_mask:0xc
  s_nop 0
  v_add_f32_dpp v13, v11, v11 row_ror:8 row_mask:0xf bank_mask:0xc
  v_add_f32_dpp v14, v12, v12 row_half_mirror row_mask:0xf bank_mask:0x5
  s_nop 1
  v_add_f32_dpp v14, v13, v13 row_half_mirror row_mask:0xf bank_mask:0xa
  ds_write_b32 v20, v14 offset:256
  s_cmp_eq_u32 s6, 3
  s_cselect_b32 s8, s40, s8
  s_cselect_b32 s9, s41, s9
  s_cselect_b32 s10, s43, s10
  s_waitcnt vmcnt(6)
  s_cmp_ge_u32 s15, 2
  s_cbranch_scc1 L_go_11
  s_waitcnt vmcnt(5)
  s_cmp_ge_u32 s15, 1
  s_cbranch_scc1 L_go_11
  s_waitcnt vmcnt(4)
L_go_11:
  buffer_load_dwordx4 v[36:39], v1, s[8:11], s12 offen offset:0 nt
  s_waitcnt vmcnt(6)
  s_cmp_ge_u32 s15, 2
  s_cbranch_scc1 L_go_12
  s_waitcnt vmcnt(5)
  s_cmp_ge_u32 s15, 1
  s_cbranch_scc1 L_go_12
  s_waitcnt vmcnt(4)
L_go_12:
  buffer_load_dwordx4 v[40:43], v1, s[8:11], s12 offen offset:1024 nt
  s_waitcnt vmcnt(6)
  s_cmp_ge_u32 s15, 2
  s_cbranch_scc1 L_go_13
  s_waitcnt vmcnt(5)
  s_cmp_ge_u32 s15, 1
  s_cbranch_scc1 L_go_13
  s_waitcnt vmcnt(4)
L_go_13:
  buffer_load_dwordx4 v[44:47], v1, s[8:11], s12 offen offset:2048 nt
  s_waitcnt vmcnt(6)
  s_cmp_ge_u32 s15, 2
  s_cbranch_scc1 L_go_14
  s_waitcnt vmcnt(5)
  s_cmp_ge_u32 s15, 1
  s_cbranch_scc1 L_go_14
  s_waitcnt vmcnt(4)
L_go_14:
  buffer_load_dwordx4 v[48:51], v1, s[8:11], s12 offen offset:3072 nt
  s_xor_b32 s12, s42, 0x8000
  s_mov_b64 exec, 1
  ds_add_u32 v3, v23 offset:44
  s_mov_b64 exec, -1
  ds_read_b32 v2, v3 offset:28
  v_dot2_f32_bf16 v8, v68, v4, 0
  v_dot2_f32_bf16 v9, v72, v4, 0
  v_dot2_f32_bf16 v10, v76, v4, 0
  v_dot2_f32_bf16 v11, v80, v4, 0
  v_dot2_f32_bf16 v8, v69, v5, v8
  v_dot2_f32_bf16 v9, v73, v5, v9
  v_dot2_f32_bf16 v10, v77, v5, v10
  v_dot2_f32_bf16 v11, v81, v5, v11
  v_dot2_f32_bf16 v8, v70, v6, v8
  v_dot2_f32_bf16 v9, v74, v6, v9
  v_dot2_f32_bf16 v10, v78, v6, v10
  v_dot2_f32_bf16 v11, v82, v6, v11
  v_dot2_f32_bf16 v8, v71, v7, v8
  v_dot2_f32_bf16 v9, v75, v7, v9
  v_dot2_f32_bf16 v10, v79, v7, v10
  v_dot2_f32_bf16 v11, v83, v7, v11
  v_add_f32_dpp v12, v8, v8 row_ror:8 row_mask:0xf bank_mask:0x3
  s_nop 0
  v_add_f32_dpp v13, v10, v10 row_ror:8 row_mask:0xf bank_mask:0x3
  v_add_f32_dpp v12, v9, v9 row_ror:8 row_mask:0xf bank_mask:0xc
  s_nop 0
  v_add_f32_dpp v13, v11, v11 row_ror:8 row_mask:0xf bank_mask:0xc
  v_add_f32_dpp v14, v12, v12 row_half_mirror row_mask:0xf bank_mask:0x5
  s_nop 1
  v_add_f32_dpp v14, v13, v13 row_half_mirror row_mask:0xf bank_mask:0xa
  ds_write_b32 v20, v14 offset:512
  s_waitcnt lgkmcnt(0)
  v_readfirstlane_b32 s45, v2
  s_sub_u32 s45, s45, 1
  s_cselect_b32 s15, s15, s45
  s_waitcnt vmcnt(6)
  s_cmp_ge_u32 s15, 2
  s_cbranch_scc1 L_go_15
  s_waitcnt vmcnt(5)
  s_cmp_ge_u32 s15, 1
  s_cbranch_scc1 L_go_15
  s_waitcnt vmcnt(4)
L_go_15:
  buffer_load_dwordx4 v[52:55], v1, s[8:11], s12 offen offset:0 nt
  s_waitcnt vmcnt(6)
  s_cmp_ge_u32 s15, 2
  s_cbranch_scc1 L_go_16
  s_waitcnt vmcnt(5)
  s_cmp_ge_u32 s15, 1
  s_cbranch_scc1 L_go_16
  s_waitcnt vmcnt(4)
L_go_16:
  buffer_load_dwordx4 v[56:59], v1, s[8:11], s12 offen offset:1024 nt
  s_waitcnt vmcnt(6)
  s_cmp_ge_u32 s15, 2
  s_cbranch_scc1 L_go_17
  s_waitcnt vmcnt(5)
  s_cmp_ge_u32 s15, 1
  s_cbranch_scc1 L_go_17
  s_waitcnt vmcnt(4)
L_go_17:
  buffer_load_dwordx4 v[60:63], v1, s[8:11], s12 offen offset:2048 nt
  s_waitcnt vmcnt(6)
  s_cmp_ge_u32 s15, 2
  s_cbranch_scc1 L_go_18
  s_waitcnt vmcnt(5)
  s_cmp_ge_u32 s15, 1
  s_cbranch_scc1 L_go_18
  s_waitcnt vmcnt(4)
L_go_18:
  buffer_load_dwordx4 v[64:67], v1, s[8:11], s12 offen offset:3072 nt
  s_xor_b32 s12, s42, 0x4000
  s_mov_b64 exec, 1
  ds_add_u32 v3, v23 offset:44
  s_mov_b64 exec, -1
  v_dot2_f32_bf16 v8, v84, v4, 0
  v_dot2_f32_bf16 v9, v88, v4, 0
  v_dot2_f32_bf16 v10, v92, v4, 0
  v_dot2_f32_bf16 v11, v96, v4, 0
  v_dot2_f32_bf16 v8, v85, v5, v8
  v_dot2_f32_bf16 v9, v89, v5, v9
  v_dot2_f32_bf16 v10, v93, v5, v10
  v_dot2_f32_bf16 v11, v97, v5, v11
  v_dot2_f32_bf16 v8, v86, v6, v8
  v_dot2_f32_bf16 v9, v90, v6, v9
  v_dot2_f32_bf16 v10, v94, v6, v10
  v_dot2_f32_bf16 v11, v98, v6, v11
  v_dot2_f32_bf16 v8, v87, v7, v8
  v_dot2_f32_bf16 v9, v91, v7, v9
  v_dot2_f32_bf16 v10, v95, v7, v10
  v_dot2_f32_bf16 v11, v99, v7, v11
  v_add_f32_dpp v12, v8, v8 row_ror:8 row_mask:0xf bank_mask:0x3
  s_nop 0
  v_add_f32_dpp v13, v10, v10 row_ror:8 row_mask:0xf bank_mask:0x3
  v_add_f32_dpp v12, v9, v9 row_ror:8 row_mask:0xf bank_mask:0xc
  s_nop 0
  v_add_f32_dpp v13, v11, v11 row_ror:8 row_mask:0xf bank_mask:0xc
  v_add_f32_dpp v14, v12, v12 row_half_mirror row_mask:0xf bank_mask:0x5
  s_nop 1
  v_add_f32_dpp v14, v13, v13 row_half_mirror row_mask:0xf bank_mask:0xa
  ds_write_b32 v20, v14 offset:768
  v_add_u32 v20, 0x400, v20
  s_add_u32 s6, s6, 1
  s_cmp_lt_u32 s6, 4
  s_cbranch_scc1 L_kiter
  s_waitcnt lgkmcnt(0)
  s_mov_b64 exec, 1
  ds_add_u32 v22, v23 offset:8
  s_mov_b64 exec, -1
  v_mov_b32 v4, v16
  v_mov_b32 v5, v17
  v_mov_b32 v6, v18
  v_mov_b32 v7, v19
  v_add_u32 v20, 0x3000, v20
  v_xor_b32 v22, 4, v22
  s_add_u32 s40, s20, s13
  s_addc_u32 s41, s21, 0
  s_mov_b32 s6, 0
  s_add_u32 s7, s7, 1
  s_cmp_lt_u32 s7, 2
  s_cbranch_scc1 L_kiter
  s_lshl_b32 s14, s3, 11
  s_add_u32 s14, s14, 34816
  v_lshlrev_b32 v20, 3, v0
  v_add_u32 v20, s14, v20
  s_lshl_b32 s14, s3, 9
  s_add_u32 s14, s14, 51200
  v_and_b32 v21, 15, v0
  v_lshlrev_b32 v21, 5, v21
  v_lshrrev_b32 v8, 4, v0
  v_lshl_add_u32 v21, v8, 3, v21
  v_add_u32 v21, s14, v21
  s_add_u32 s40, s40, 0x4000000
  s_addc_u32 s41, s41, 0
  s_mov_b32 s7, 0
  s_mov_b32 s44, 99
L_vhead:
  s_mov_b32 s60, 4000000
L_lw_19:
  ds_read_b32 v8, v22 offset:16
  s_waitcnt lgkmcnt(0)
  v_cmp_gt_u32 vcc, 1, v8
  s_cbranch_vccz L_lwd_20
  s_sleep 1
  s_sub_u32 s60, s60, 1
  s_cbranch_scc0 L_lw_19
L_lwd_20:
  v_mov_b32 v24, 0
  v_mov_b32 v25, 0
  v_mov_b32 v26, 0
  v_mov_b32 v27, 0
  v_mov_b32 v28, 0
  v_mov_b32 v29, 0
  v_mov_b32 v30, 0
  v_mov_b32 v31, 0
  s_mov_b32 s6, 0
L_viter:
  ds_read_b64 v[32:33], v20
  s_cmp_ge_u32 s6, s44
  s_cselect_b32 s15, 2, s15
  s_waitcnt vmcnt(6)
  s_cmp_ge_u32 s15, 2
  s_cbranch_scc1 L_go_21
  s_waitcnt vmcnt(5)
  s_cmp_ge_u32 s15, 1
  s_cbranch_scc1 L_go_21
  s_waitcnt vmcnt(4)
L_go_21:
  buffer_load_dwordx4 v[68:71], v1, s[8:11], s12 offen offset:0 nt
  s_waitcnt vmcnt(6)
  s_cmp_ge_u32 s15, 2
  s_cbranch_scc1 L_go_22
  s_waitcnt vmcnt(5)
  s_cmp_ge_u32 s15, 1
  s_cbranch_scc1 L_go_22
  s_waitcnt vmcnt(4)
L_go_22:
  buffer_load_dwordx4 v[72:75], v1, s[8:11], s12 offen offset:1024 nt
  s_waitcnt vmcnt(6)
  s_cmp_ge_u32 s15, 2
  s_cbranch_scc1 L_go_23
  s_waitcnt vmcnt(5)
  s_cmp_ge_u32 s15, 1
  s_cbranch_scc1 L_go_23
  s_waitcnt vmcnt(4)
L_go_23:
  buffer_load_dwordx4 v[76:79], v1, s[8:11], s12 offen offset:2048 nt
  s_waitcnt vmcnt(6)
  s_cmp_ge_u32 s15, 2
  s_cbranch_scc1 L_go_24
  s_waitcnt vmcnt(5)
  s_cmp_ge_u32 s15, 1
  s_cbranch_scc1 L_go_24
  s_waitcnt vmcnt(4)
L_go_24:
  buffer_load_dwordx4 v[80:83], v1, s[8:11], s12 offen offset:3072 nt
  s_xor_b32 s12, s42, 0xc000
  s_waitcnt lgkmcnt(0)
  s_mov_b64 exec, 1
  ds_add_u32 v3, v23 offset:44
  s_mov_b64 exec, -1
  ds_read_b32 v2, v3 offset:28
  v_dot2c_f32_bf16_dpp v24, v32, v36 row_newbcast:0 row_mask:0xf bank_mask:0xf
  v_dot2c_f32_bf16_dpp v25, v33, v36 row_newbcast:0 row_mask:0xf bank_mask:0xf
  v_dot2c_f32_bf16_dpp v26, v32, v37 row_newbcast:0 row_mask:0xf bank_mask:0xf
  v_dot2c_f32_bf16_dpp v27, v33, v37 row_newbcast:0 row_mask:0xf bank_mask:0xf
  v_dot2c_f32_bf16_dpp v28, v32, v38 row_newbcast:0 row_mask:0xf bank_mask:0xf
  v_dot2c_f32_bf16_dpp v29, v33, v38 row_newbcast:0 row_mask:0xf bank_mask:0xf
  v_dot2c_f32_bf16_dpp v30, v32, v39 row_newbcast:0 row_mask:0xf bank_mask:0xf
  v_dot2c_f32_bf16_dpp v31, v33, v39 row_newbcast:0 row_mask:0xf bank_mask:0xf
  v_dot2c_f32_bf16_dpp v24, v32, v40 row_newbcast:8 row_mask:0xf bank_mask:0xf
  v_dot2c_f32_bf16_dpp v25, v33, v40 row_newbcast:8 row_mask:0xf bank_mask:0xf
  v_dot2c_f32_bf16_dpp v26, v32, v41 row_newbcast:8 row_mask:0xf bank_mask:0xf
  v_dot2c_f32_bf16_dpp v27, v33, v41 row_newbcast:8 row_mask:0xf bank_mask:0xf
  v_dot2c_f32_bf16_dpp v28, v32, v42 row_newbcast:8 row_mask:0xf bank_mask:0xf
  v_dot2c_f32_bf16_dpp v29, v33, v42 row_newbcast:8 row_mask:0xf bank_mask:0xf
  v_dot2c_f32_bf16_dpp v30, v32, v43 row_newbcast:8 row_mask:0xf bank_mask:0xf
  v_dot2c_f32_bf16_dpp v31, v33, v43 row_newbcast:8 row_mask:0xf bank_mask:0xf
  v_dot2c_f32_bf16_dpp v24, v32, v44 row_newbcast:4 row_mask:0xf bank_mask:0xf
  v_dot2c_f32_bf16_dpp v25, v33, v44 row_newbcast:4 row_mask:0xf bank_mask:0xf
  v_dot2c_f32_bf16_dpp v26, v32, v45 row_newbcast:4 row_mask:0xf bank_mask:0xf
  v_dot2c_f32_bf16_dpp v27, v33, v45 row_newbcast:4 row_mask:0xf bank_mask:0xf
  v_dot2c_f32_bf16_dpp v28, v32, v46 row_newbcast:4 row_mask:0xf bank_mask:0xf
  v_dot2c_f32_bf16_dpp v29, v33, v46 row_newbcast:4 row_mask:0xf bank_mask:0xf
  v_dot2c_f32_bf16_dpp v30, v32, v47 row_newbcast:4 row_mask:0xf bank_mask:0xf
  v_dot2c_f32_bf16_dpp v31, v33, v47 row_newbcast:4 row_mask:0xf bank_mask:0xf
  v_dot2c_f32_bf16_dpp v24, v32, v48 row_newbcast:12 row_mask:0xf bank_mask:0xf
  v_dot2c_f32_bf16_dpp v25, v33, v48 row_newbcast:12 row_mask:0xf bank_mask:0xf
  v_dot2c_f32_bf16_dpp v26, v32, v49 row_newbcast:12 row_mask:0xf bank_mask:0xf
  v_dot2c_f32_bf16_dpp v27, v33, v49 row_newbcast:12 row_mask:0xf bank_mask:0xf
  v_dot2c_f32_bf16_dpp v28, v32, v50 row_newbcast:12 row_mask:0xf bank_mask:0xf
  v_dot2c_f32_bf16_dpp v29, v33, v50 row_newbcast:12 row_mask:0xf bank_mask:0xf
  v_dot2c_f32_bf16_dpp v30, v32, v51 row_newbcast:12 row_mask:0xf bank_mask:0xf
  v_dot2c_f32_bf16_dpp v31, v33, v51 row_newbcast:12 row_mask:0xf bank_mask:0xf
  s_waitcnt lgkmcnt(0)
  v_readfirstlane_b32 s45, v2
  s_sub_u32 s45, s45, 1
  s_cselect_b32 s15, s15, s45
  s_cmp_ge_u32 s6, s44
  s_cselect_b32 s15, 2, s15
  s_waitcnt vmcnt(6)
  s_cmp_ge_u32 s15, 2
  s_cbranch_scc1 L_go_25
  s_waitcnt vmcnt(5)
  s_cmp_ge_u32 s15, 1
  s_cbranch_scc1 L_go_25
  s_waitcnt vmcnt(4)
L_go_25:
  buffer_load_dwordx4 v[84:87], v1, s[8:11], s12 offen offset:0 nt
  s_waitcnt vmcnt(6)
  s_cmp_ge_u32 s15, 2
  s_cbranch_scc1 L_go_26
  s_waitcnt vmcnt(5)
  s_cmp_ge_u32 s15, 1
  s_cbranch_scc1 L_go_26
  s_waitcnt vmcnt(4)
L_go_26:
  buffer_load_dwordx4 v[88:91], v1, s[8:11], s12 offen offset:1024 nt
  s_waitcnt vmcnt(6)
  s_cmp_ge_u32 s15, 2
  s_cbranch_scc1 L_go_27
  s_waitcnt vmcnt(5)
  s_cmp_ge_u32 s15, 1
  s_cbranch_scc1 L_go_27
  s_waitcnt vmcnt(4)
L_go_27:
  buffer_load_dwordx4 v[92:95], v1, s[8:11], s12 offen offset:2048 nt
  s_waitcnt vmcnt(6)
  s_cmp_ge_u32 s15, 2
  s_cbranch_scc1 L_go_28
  s_waitcnt vmcnt(5)
  s_cmp_ge_u32 s15, 1
  s_cbranch_scc1 L_go_28
  s_waitcnt vmcnt(4)
L_go_28:
  buffer_load_dwordx4 v[96:99], v1, s[8:11], s12 offen offset:3072 nt
  s_add_u32 s42, s42, 0xe0000
  s_and_b32 s42, s42, 0x120000
  s_xor_b32 s12, s42, 0x0
  s_mov_b64 exec, 1
  ds_add_u32 v3, v23 offset:44
  s_mov_b64 exec, -1
  v_dot2c_f32_bf16_dpp v24, v32, v52 row_newbcast:1 row_mask:0xf bank_mask:0xf
  v_dot2c_f32_bf16_dpp v25, v33, v52 row_newbcast:1 row_mask:0xf bank_mask:0xf
  v_dot2c_f32_bf16_dpp v26, v32, v53 row_newbcast:1 row_mask:0xf bank_mask:0xf
  v_dot2c_f32_bf16_dpp v27, v33, v53 row_newbcast:1 row_mask:0xf bank_mask:0xf
  v_dot2c_f32_bf16_dpp v28, v32, v54 row_newbcast:1 row_mask:0xf bank_mask:0xf
  v_dot2c_f32_bf16_dpp v29, v33, v54 row_newbcast:1 row_mask:0xf bank_mask:0xf
  v_dot2c_f32_bf16_dpp v30, v32, v55 row_newbcast:1 row_mask:0xf bank_mask:0xf
  v_dot2c_f32_bf16_dpp v31, v33, v55 row_newbcast:1 row_mask:0xf bank_mask:0xf
  v_dot2c_f32_bf16_dpp v24, v32, v56 row_newbcast:9 row_mask:0xf bank_mask:0xf
  v_dot2c_f32_bf16_dpp v25, v33, v56 row_newbcast:9 row_mask:0xf bank_mask:0xf
  v_dot2c_f32_bf16_dpp v26, v32, v57 row_newbcast:9 row_mask:0xf bank_mask:0xf
  v_dot2c_f32_bf16_dpp v27, v33, v57 row_newbcast:9 row_mask:0xf bank_mask:0xf
  v_dot2c_f32_bf16_dpp v28, v32, v58 row_newbcast:9 row_mask:0xf bank_mask:0xf
  v_dot2c_f32_bf16_dpp v29, v33, v58 row_newbcast:9 row_mask:0xf bank_mask:0xf
  v_dot2c_f32_bf16_dpp v30, v32, v59 row_newbcast:9 row_mask:0xf bank_mask:0xf
  v_dot2c_f32_bf16_dpp v31, v33, v59 row_newbcast:9 row_mask:0xf bank_mask:0xf
  v_dot2c_f32_bf16_dpp v24, v32, v60 row_newbcast:5 row_mask:0xf bank_mask:0xf
  v_dot2c_f32_bf16_dpp v25, v33, v60 row_newbcast:5 row_mask:0xf bank_mask:0xf
  v_dot2c_f32_bf16_dpp v26, v32, v61 row_newbcast:5 row_mask:0xf bank_mask:0xf
  v_dot2c_f32_bf16_dpp v27, v33, v61 row_newbcast:5 row_mask:0xf bank_mask:0xf
  v_dot2c_f32_bf16_dpp v28, v32, v62 row_newbcast:5 row_mask:0xf bank_mask:0xf
  v_dot2c_f32_bf16_dpp v29, v33, v62 row_newbcast:5 row_mask:0xf bank_mask:0xf
  v_dot2c_f32_bf16_dpp v30, v32, v63 row_newbcast:5 row_mask:0xf bank_mask:0xf
  v_dot2c_f32_bf16_dpp v31, v33, v63 row_newbcast:5 row_mask:0xf bank_mask:0xf
  v_dot2c_f32_bf16_dpp v24, v32, v64 row_newbcast:13 row_mask:0xf bank_mask:0xf
  v_dot2c_f32_bf16_dpp v25, v33, v64 row_newbcast:13 row_mask:0xf bank_mask:0xf
  v_dot2c_f32_bf16_dpp v26, v32, v65 row_newbcast:13 row_mask:0xf bank_mask:0xf
  v_dot2c_f32_bf16_dpp v27, v33, v65 row_newbcast:13 row_mask:0xf bank_mask:0xf
  v_dot2c_f32_bf16_dpp v28, v32, v66 row_newbcast:13 row_mask:0xf bank_mask:0xf
  v_dot2c_f32_bf16_dpp v29, v33, v66 row_newbcast:13 row_mask:0xf bank_mask:0xf
  v_dot2c_f32_bf16_dpp v30, v32, v67 row_newbcast:13 row_mask:0xf bank_mask:0xf
  v_dot2c_f32_bf16_dpp v31, v33, v67 row_newbcast:13 row_mask:0xf bank_mask:0xf
  s_cmp_eq_u32 s6, 3
  s_cselect_b32 s8, s40, s8
  s_cselect_b32 s9, s41, s9
  s_cselect_b32 s10, s43, s10
  s_cmp_eq_u32 s10, 0
  s_cbranch_scc1 L_drain_29
  s_waitcnt vmcnt(6)
  s_cmp_ge_u32 s15, 2
  s_cbranch_scc1 L_go_31
  s_waitcnt vmcnt(5)
  s_cmp_ge_u32 s15, 1
  s_cbranch_scc1 L_go_31
  s_waitcnt vmcnt(4)
L_go_31:
  buffer_load_dwordx4 v[36:39], v1, s[8:11], s12 offen offset:0 nt
  s_waitcnt vmcnt(6)
  s_cmp_ge_u32 s15, 2
  s_cbranch_scc1 L_go_32
  s_waitcnt vmcnt(5)
  s_cmp_ge_u32 s15, 1
  s_cbranch_scc1 L_go_32
  s_waitcnt vmcnt(4)
L_go_32:
  buffer_load_dwordx4 v[40:43], v1, s[8:11], s12 offen offset:1024 nt
  s_waitcnt vmcnt(6)
  s_cmp_ge_u32 s15, 2
  s_cbranch_scc1 L_go_33
  s_waitcnt vmcnt(5)
  s_cmp_ge_u32 s15, 1
  s_cbranch_scc1 L_go_33
  s_waitcnt vmcnt(4)
L_go_33:
  buffer_load_dwordx4 v[44:47], v1, s[8:11], s12 offen offset:2048 nt
  s_waitcnt vmcnt(6)
  s_cmp_ge_u32 s15, 2
  s_cbranch_scc1 L_go_34
  s_waitcnt vmcnt(5)
  s_cmp_ge_u32 s15, 1
  s_cbranch_scc1 L_go_34
  s_waitcnt vmcnt(4)
L_go_34:
  buffer_load_dwordx4 v[48:51], v1, s[8:11], s12 offen offset:3072 nt
  s_xor_b32 s12, s42, 0x8000
  s_branch L_drained_30
L_drain_29:
  s_waitcnt vmcnt(4)
L_drained_30:
  s_mov_b64 exec, 1
  ds_add_u32 v3, v23 offset:44
  s_mov_b64 exec, -1
  ds_read_b32 v2, v3 offset:28
  v_dot2c_f32_bf16_dpp v24, v32, v68 row_newbcast:2 row_mask:0xf bank_mask:0xf
  v_dot2c_f32_bf16_dpp v25, v33, v68 row_newbcast:2 row_mask:0xf bank_mask:0xf
  v_dot2c_f32_bf16_dpp v26, v32, v69 row_newbcast:2 row_mask:0xf bank_mask:0xf
  v_dot2c_f32_bf16_dpp v27, v33, v69 row_newbcast:2 row_mask:0xf bank_mask:0xf
  v_dot2c_f32_bf16_dpp v28, v32, v70 row_newbcast:2 row_mask:0xf bank_mask:0xf
  v_dot2c_f32_bf16_dpp v29, v33, v70 row_newbcast:2 row_mask:0xf bank_mask:0xf
  v_dot2c_f32_bf16_dpp v30, v32, v71 row_newbcast:2 row_mask:0xf bank_mask:0xf
  v_dot2c_f32_bf16_dpp v31, v33, v71 row_newbcast:2 row_mask:0xf bank_mask:0xf
  v_dot2c_f32_bf16_dpp v24, v32, v72 row_newbcast:10 row_mask:0xf bank_mask:0xf
  v_dot2c_f32_bf16_dpp v25, v33, v72 row_newbcast:10 row_mask:0xf bank_mask:0xf
  v_dot2c_f32_bf16_dpp v26, v32, v73 row_newbcast:10 row_mask:0xf bank_mask:0xf
  v_dot2c_f32_bf16_dpp v27, v33, v73 row_newbcast:10 row_mask:0xf bank_mask:0xf
  v_dot2c_f32_bf16_dpp v28, v32, v74 row_newbcast:10 row_mask:0xf bank_mask:0xf
  v_dot2c_f32_bf16_dpp v29, v33, v74 row_newbcast:10 row_mask:0xf bank_mask:0xf
  v_dot2c_f32_bf16_dpp v30, v32, v75 row_newbcast:10 row_mask:0xf bank_mask:0xf
  v_dot2c_f32_bf16_dpp v31, v33, v75 row_newbcast:10 row_mask:0xf bank_mask:0xf
  v_dot2c_f32_bf16_dpp v24, v32, v76 row_newbcast:6 row_mask:0xf bank_mask:0xf
  v_dot2c_f32_bf16_dpp v25, v33, v76 row_newbcast:6 row_mask:0xf bank_mask:0xf
  v_dot2c_f32_bf16_dpp v26, v32, v77 row_newbcast:6 row_mask:0xf bank_mask:0xf
  v_dot2c_f32_bf16_dpp v27, v33, v77 row_newbcast:6 row_mask:0xf bank_mask:0xf
  v_dot2c_f32_bf16_dpp v28, v32, v78 row_newbcast:6 row_mask:0xf bank_mask:0xf
  v_dot2c_f32_bf16_dpp v29, v33, v78 row_newbcast:6 row_mask:0xf bank_mask:0xf
  v_dot2c_f32_bf16_dpp v30, v32, v79 row_newbcast:6 row_mask:0xf bank_mask:0xf
  v_dot2c_f32_bf16_dpp v31, v33, v79 row_newbcast:6 row_mask:0xf bank_mask:0xf
  v_dot2c_f32_bf16_dpp v24, v32, v80 row_newbcast:14 row_mask:0xf bank_mask:0xf
  v_dot2c_f32_bf16_dpp v25, v33, v80 row_newbcast:14 row_mask:0xf bank_mask:0xf
  v_dot2c_f32_bf16_dpp v26, v32, v81 row_newbcast:14 row_mask:0xf bank_mask:0xf
  v_dot2c_f32_bf16_dpp v27, v33, v81 row_newbcast:14 row_mask:0xf bank_mask:0xf
  v_dot2c_f32_bf16_dpp v28, v32, v82 row_newbcast:14 row_mask:0xf bank_mask:0xf
  v_dot2c_f32_bf16_dpp v29, v33, v82 row_newbcast:14 row_mask:0xf bank_mask:0xf
  v_dot2c_f32_bf16_dpp v30, v32, v83 row_newbcast:14 row_mask:0xf bank_mask:0xf
  v_dot2c_f32_bf16_dpp v31, v33, v83 row_newbcast:14 row_mask:0xf bank_mask:0xf
  s_waitcnt lgkmcnt(0)
  v_readfirstlane_b32 s45, v2
  s_sub_u32 s45, s45, 1
  s_cselect_b32 s15, s15, s45
  s_cmp_ge_u32 s6, s44
  s_cselect_b32 s15, 2, s15
  s_cmp_eq_u32 s10, 0
  s_cbranch_scc1 L_drain_35
  s_waitcnt vmcnt(6)
  s_cmp_ge_u32 s15, 2
  s_cbranch_scc1 L_go_37
  s_waitcnt vmcnt(5)
  s_cmp_ge_u32 s15, 1
  s_cbranch_scc1 L_go_37
  s_waitcnt vmcnt(4)
L_go_37:
  buffer_load_dwordx4 v[52:55], v1, s[8:11], s12 offen offset:0 nt
  s_waitcnt vmcnt(6)
  s_cmp_ge_u32 s15, 2
  s_cbranch_scc1 L_go_38
  s_waitcnt vmcnt(5)
  s_cmp_ge_u32 s15, 1
  s_cbranch_scc1 L_go_38
  s_waitcnt vmcnt(4)
L_go_38:
  buffer_load_dwordx4 v[56:59], v1, s[8:11], s12 offen offset:1024 nt
  s_waitcnt vmcnt(6)
  s_cmp_ge_u32 s15, 2
  s_cbranch_scc1 L_go_39
  s_waitcnt vmcnt(5)
  s_cmp_ge_u32 s15, 1
  s_cbranch_scc1 L_go_39
  s_waitcnt vmcnt(4)
L_go_39:
  buffer_load_dwordx4 v[60:63], v1, s[8:11], s12 offen offset:2048 nt
  s_waitcnt vmcnt(6)
  s_cmp_ge_u32 s15, 2
  s_cbranch_scc1 L_go_40
  s_waitcnt vmcnt(5)
  s_cmp_ge_u32 s15, 1
  s_cbranch_scc1 L_go_40
  s_waitcnt vmcnt(4)
L_go_40:
  buffer_load_dwordx4 v[64:67], v1, s[8:11], s12 offen offset:3072 nt
  s_xor_b32 s12, s42, 0x4000
  s_branch L_drained_36
L_drain_35:
  s_waitcnt vmcnt(0)
L_drained_36:
  s_mov_b64 exec, 1
  ds_add_u32 v3, v23 offset:44
  s_mov_b64 exec, -1
  v_dot2c_f32_bf16_dpp v24, v32, v84 row_newbcast:3 row_mask:0xf bank_mask:0xf
  v_dot2c_f32_bf16_dpp v25, v33, v84 row_newbcast:3 row_mask:0xf bank_mask:0xf
  v_dot2c_f32_bf16_dpp v26, v32, v85 row_newbcast:3 row_mask:0xf bank_mask:0xf
  v_dot2c_f32_bf16_dpp v27, v33, v85 row_newbcast:3 row_mask:0xf bank_mask:0xf
  v_dot2c_f32_bf16_dpp v28, v32, v86 row_newbcast:3 row_mask:0xf bank_mask:0xf
  v_dot2c_f32_bf16_dpp v29, v33, v86 row_newbcast:3 row_mask:0xf bank_mask:0xf
  v_dot2c_f32_bf16_dpp v30, v32, v87 row_newbcast:3 row_mask:0xf bank_mask:0xf
  v_dot2c_f32_bf16_dpp v31, v33, v87 row_newbcast:3 row_mask:0xf bank_mask:0xf
  v_dot2c_f32_bf16_dpp v24, v32, v88 row_newbcast:11 row_mask:0xf bank_mask:0xf
  v_dot2c_f32_bf16_dpp v25, v33, v88 row_newbcast:11 row_mask:0xf bank_mask:0xf
  v_dot2c_f32_bf16_dpp v26, v32, v89 row_newbcast:11 row_mask:0xf bank_mask:0xf
  v_dot2c_f32_bf16_dpp v27, v33, v89 row_newbcast:11 row_mask:0xf bank_mask:0xf
  v_dot2c_f32_bf16_dpp v28, v32, v90 row_newbcast:11 row_mask:0xf bank_mask:0xf
  v_dot2c_f32_bf16_dpp v29, v33, v90 row_newbcast:11 row_mask:0xf bank_mask:0xf
  v_dot2c_f32_bf16_dpp v30, v32, v91 row_newbcast:11 row_mask:0xf bank_mask:0xf
  v_dot2c_f32_bf16_dpp v31, v33, v91 row_newbcast:11 row_mask:0xf bank_mask:0xf
  v_dot2c_f32_bf16_dpp v24, v32, v92 row_newbcast:7 row_mask:0xf bank_mask:0xf
  v_dot2c_f32_bf16_dpp v25, v33, v92 row_newbcast:7 row_mask:0xf bank_mask:0xf
  v_dot2c_f32_bf16_dpp v26, v32, v93 row_newbcast:7 row_mask:0xf bank_mask:0xf
  v_dot2c_f32_bf16_dpp v27, v33, v93 row_newbcast:7 row_mask:0xf bank_mask:0xf
  v_dot2c_f32_bf16_dpp v28, v32, v94 row_newbcast:7 row_mask:0xf bank_mask:0xf
  v_dot2c_f32_bf16_dpp v29, v33, v94 row_newbcast:7 row_mask:0xf bank_mask:0xf
  v_dot2c_f32_bf16_dpp v30, v32, v95 row_newbcast:7 row_mask:0xf bank_mask:0xf
  v_dot2c_f32_bf16_dpp v31, v33, v95 row_newbcast:7 row_mask:0xf bank_mask:0xf
  v_dot2c_f32_bf16_dpp v24, v32, v96 row_newbcast:15 row_mask:0xf bank_mask:0xf
  v_dot2c_f32_bf16_dpp v25, v33, v96 row_newbcast:15 row_mask:0xf bank_mask:0xf
  v_dot2c_f32_bf16_dpp v26, v32, v97 row_newbcast:15 row_mask:0xf bank_mask:0xf
  v_dot2c_f32_bf16_dpp v27, v33, v97 row_newbcast:15 row_mask:0xf bank_mask:0xf
  v_dot2c_f32_bf16_dpp v28, v32, v98 row_newbcast:15 row_mask:0xf bank_mask:0xf
  v_dot2c_f32_bf16_dpp v29, v33, v98 row_newbcast:15 row_mask:0xf bank_mask:0xf
  v_dot2c_f32_bf16_dpp v30, v32, v99 row_newbcast:15 row_mask:0xf bank_mask:0xf
  v_dot2c_f32_bf16_dpp v31, v33, v99 row_newbcast:15 row_mask:0xf bank_mask:0xf
  v_add_u32 v20, 0x200, v20
  s_add_u32 s6, s6, 1
  s_cmp_lt_u32 s6, 4
  s_cbranch_scc1 L_viter
  v_permlane32_swap_b32 v24, v28
  v_permlane32_swap_b32 v25, v29
  v_permlane32_swap_b32 v26, v30
  v_permlane32_swap_b32 v27, v31
  v_add_f32 v24, v24, v28
  v_add_f32 v25, v25, v29
  v_add_f32 v26, v26, v30
  v_add_f32 v27, v27, v31
  s_nop 0
  v_permlane16_swap_b32 v24, v26
  v_permlane16_swap_b32 v25, v27
  v_add_f32 v34, v24, v26
  v_add_f32 v35, v25, v27
  ds_write_b64 v21, v[34:35]
  s_cmp_lg_u32 s7, 0
  s_cbranch_scc1 L_vend
  s_waitcnt lgkmcnt(0)
  s_mov_b64 exec, 1
  ds_add_u32 v22, v23 offset:24
  s_mov_b64 exec, -1
  v_add_u32 v20, 0x1800, v20
  v_add_u32 v21, 0x800, v21
  v_mov_b32 v22, 4
  s_mov_b32 s43, 0
  s_mov_b32 s7, 1
  s_mov_b32 s44, 3
  s_branch L_vhead
L_vend:
  s_mov_b64 exec, 1
  ds_add_u32 v3, v23 offset:48
  s_mov_b64 exec, -1
  s_sub_u32 s12, s67, 160
  s_cmp_ge_u32 s12, 54
  s_cbranch_scc1 L_fin
  s_cmp_eq_u32 s3, 0
  s_cbranch_scc1 L_lnstat
  s_branch L_fin
L_helper:
  s_sub_u32 s3, s3, 4
  s_and_b32 s6, s2, 15
  s_sub_u32 s52, s67, 160
  s_and_b32 s53, s52, 1
  s_lshl_b32 s53, s53, 2
  s_xor_b32 s53, s53, s3
  v_lshlrev_b32 v6, 2, v0
  v_mov_b32 v14, 0
  v_mov_b32 v15, 1
  s_mov_b32 s70, 0x05040100
  s_mov_b32 s71, 0x07060302
  s_cmp_ge_u32 s3, 4
  s_cbranch_scc1 L_helper2
  s_setprio 3
  v_lshrrev_b32 v2, 3, v0
  v_and_b32 v3, 7, v0
  v_mul_u32_u24 v4, 5, v2
  s_lshr_b32 s8, s6, 2
  s_lshl_b32 s8, s8, 2
  s_add_u32 s8, s8, s3
  s_mul_i32 s8, s8, 40
  v_add_u32 v4, s8, v4
  v_lshlrev_b32 v5, 13, v4
  v_lshl_add_u32 v5, v3, 4, v5
  v_lshlrev_b32 v4, 1, v4
  s_lshr_b32 s9, s4, 1
  s_and_b32 s10, s9, 4
  s_add_u32 s9, s9, s10
  s_and_b32 s10, s4, 1
  s_lshl_b32 s10, s10, 2
  s_or_b32 s9, s9, s10
  s_lshl_b32 s9, s9, 8
  s_and_b32 s10, s6, 1
  s_lshl_b32 s10, s10, 7
  s_add_u32 s9, s9, s10
  s_and_b32 s10, s6, 2
  s_lshl_b32 s10, s10, 11
  s_add_u32 s9, s9, s10
  s_mov_b32 s46, 5242880
  s_mov_b32 s47, 0x20000
  s_waitcnt lgkmcnt(0)
  s_add_u32 s74, s38, 1114112
  s_addc_u32 s75, s39, 0
  s_load_dword s15, s[74:75], 0
  global_load_dwordx4 v[16:19], v1, s[16:17]
  global_load_dword v20, v6, s[16:17] offset:1024
  global_load_ushort v21, v4, s[16:17] offset:0
  global_load_ushort v22, v4, s[16:17] offset:2
  global_load_ushort v23, v4, s[16:17] offset:4
  global_load_ushort v24, v4, s[16:17] offset:6
  global_load_ushort v25, v4, s[16:17] offset:8
  s_mov_b32 s44, s22
  s_mov_b32 s45, s23
  buffer_load_dwordx4 v[64:67], v5, s[44:47], s9 offen nt
  s_add_u32 s9, s9, 0x2000
  buffer_load_dwordx4 v[68:71], v5, s[44:47], s9 offen nt
  s_add_u32 s9, s9, 0x2000
  buffer_load_dwordx4 v[72:75], v5, s[44:47], s9 offen nt
  s_add_u32 s9, s9, 0x2000
  buffer_load_dwordx4 v[76:79], v5, s[44:47], s9 offen nt
  s_add_u32 s9, s9, 0x2000
  buffer_load_dwordx4 v[80:83], v5, s[44:47], s9 offen nt
  s_barrier
  v_lshlrev_b32 v12, 2, v2
  v_lshl_add_u32 v12, v3, 5, v12
  s_lshl_b32 s12, s3, 8
  v_add_u32 v12, s12, v12
  s_mov_b32 s62, 0xff00ff00
  s_mov_b32 s63, 0xff00ff00
  s_waitcnt vmcnt(5)
  v_and_b32 v31, 0xffff0000, v16
  v_lshlrev_b32 v30, 16, v16
  v_and_b32 v33, 0xffff0000, v17
  v_lshlrev_b32 v32, 16, v17
  v_and_b32 v35, 0xffff0000, v18
  v_lshlrev_b32 v34, 16, v18
  v_and_b32 v37, 0xffff0000, v19
  v_lshlrev_b32 v36, 16, v19
  v_and_b32 v39, 0xffff0000, v20
  v_lshlrev_b32 v38, 16, v20
  v_add_f32 v26, v30, v31
  v_add_f32 v26, v26, v32
  v_add_f32 v26, v26, v33
  v_add_f32 v26, v26, v34
  v_add_f32 v26, v26, v35
  v_add_f32 v26, v26, v36
  v_add_f32 v26, v26, v37
  v_add_f32 v26, v26, v38
  v_add_f32 v26, v26, v39
  s_nop 1
  v_add_f32_dpp v26, v26, v26 row_ror:8 row_mask:0xf bank_mask:0xf
  s_nop 1
  v_add_f32_dpp v26, v26, v26 row_ror:4 row_mask:0xf bank_mask:0xf
  s_nop 1
  v_add_f32_dpp v26, v26, v26 row_ror:2 row_mask:0xf bank_mask:0xf
  s_nop 1
  v_add_f32_dpp v26, v26, v26 row_ror:1 row_mask:0xf bank_mask:0xf
  v_mov_b32 v28, v26
  s_nop 1
  v_permlane16_swap_b32 v26, v28
  v_add_f32 v26, v26, v28
  v_mov_b32 v28, v26
  s_nop 1
  v_permlane32_swap_b32 v26, v28
  v_add_f32 v26, v26, v28
  v_mul_f32 v26, 0x3acccccd, v26
  v_sub_f32 v28, v30, v26
  v_mul_f32 v27, v28, v28
  v_sub_f32 v28, v31, v26
  v_fmac_f32 v27, v28, v28
  v_sub_f32 v28, v32, v26
  v_fmac_f32 v27, v28, v28
  v_sub_f32 v28, v33, v26
  v_fmac_f32 v27, v28, v28
  v_sub_f32 v28, v34, v26
  v_fmac_f32 v27, v28, v28
  v_sub_f32 v28, v35, v26
  v_fmac_f32 v27, v28, v28
  v_sub_f32 v28, v36, v26
  v_fmac_f32 v27, v28, v28
  v_sub_f32 v28, v37, v26
  v_fmac_f32 v27, v28, v28
  v_sub_f32 v28, v38, v26
  v_fmac_f32 v27, v28, v28
  v_sub_f32 v28, v39, v26
  v_fmac_f32 v27, v28, v28
  s_nop 1
  v_add_f32_dpp v27, v27, v27 row_ror:8 row_mask:0xf bank_mask:0xf
  s_nop 1
  v_add_f32_dpp v27, v27, v27 row_ror:4 row_mask:0xf bank_mask:0xf
  s_nop 1
  v_add_f32_dpp v27, v27, v27 row_ror:2 row_mask:0xf bank_mask:0xf
  s_nop 1
  v_add_f32_dpp v27, v27, v27 row_ror:1 row_mask:0xf bank_mask:0xf
  v_mov_b32 v28, v27
  s_nop 1
  v_permlane16_swap_b32 v27, v28
  v_add_f32 v27, v27, v28
  v_mov_b32 v28, v27
  s_nop 1
  v_permlane32_swap_b32 v27, v28
  v_add_f32 v27, v27, v28
  v_mul_f32 v27, 0x3acccccd, v27
  v_cvt_pk_bf16_f32 v27, v27, v27
  v_and_b32 v27, 0xffff0000, v27
  v_cvt_pk_bf16_f32 v26, v26, v26
  v_and_b32 v26, 0xffff0000, v26
  v_add_f32 v27, 0x3727c5ac, v27
  v_cvt_pk_bf16_f32 v27, v27, v27
  v_and_b32 v27, 0xffff0000, v27
  v_sqrt_f32 v27, v27
  s_nop 0
  v_cvt_pk_bf16_f32 v27, v27, v27
  v_and_b32 v27, 0xffff0000, v27
  v_rcp_f32 v27, v27
  v_lshlrev_b32 v21, 16, v21
  v_sub_f32 v21, v21, v26
  v_cvt_pk_bf16_f32 v21, v21, v21
  v_and_b32 v21, 0xffff0000, v21
  v_mul_f32 v21, v21, v27
  v_cvt_pk_bf16_f32 v30, v21, 0
  v_cvt_pk_bf16_f32 v35, 0, v21
  v_lshlrev_b32 v22, 16, v22
  v_sub_f32 v22, v22, v26
  v_cvt_pk_bf16_f32 v22, v22, v22
  v_and_b32 v22, 0xffff0000, v22
  v_mul_f32 v22, v22, v27
  v_cvt_pk_bf16_f32 v31, v22, 0
  v_cvt_pk_bf16_f32 v36, 0, v22
  v_lshlrev_b32 v23, 16, v23
  v_sub_f32 v23, v23, v26
  v_cvt_pk_bf16_f32 v23, v23, v23
  v_and_b32 v23, 0xffff0000, v23
  v_mul_f32 v23, v23, v27
  v_cvt_pk_bf16_f32 v32, v23, 0
  v_cvt_pk_bf16_f32 v37, 0, v23
  v_lshlrev_b32 v24, 16, v24
  v_sub_f32 v24, v24, v26
  v_cvt_pk_bf16_f32 v24, v24, v24
  v_and_b32 v24, 0xffff0000, v24
  v_mul_f32 v24, v24, v27
  v_cvt_pk_bf16_f32 v33, v24, 0
  v_cvt_pk_bf16_f32 v38, 0, v24
  v_lshlrev_b32 v25, 16, v25
  v_sub_f32 v25, v25, v26
  v_cvt_pk_bf16_f32 v25, v25, v25
  v_and_b32 v25, 0xffff0000, v25
  v_mul_f32 v25, v25, v27
  v_cvt_pk_bf16_f32 v34, v25, 0
  v_cvt_pk_bf16_f32 v39, 0, v25
  v_mov_b32 v40, 0
  v_mov_b32 v41, 0
  v_mov_b32 v42, 0
  v_mov_b32 v43, 0
  v_mov_b32 v44, 0
  v_mov_b32 v45, 0
  v_mov_b32 v46, 0
  v_mov_b32 v47, 0
  s_waitcnt vmcnt(4)
  v_dot2c_f32_bf16 v40, v30, v64
  v_dot2c_f32_bf16 v41, v35, v64
  v_dot2c_f32_bf16 v42, v30, v65
  v_dot2c_f32_bf16 v43, v35, v65
  v_dot2c_f32_bf16 v44, v30, v66
  v_dot2c_f32_bf16 v45, v35, v66
  v_dot2c_f32_bf16 v46, v30, v67
  v_dot2c_f32_bf16 v47, v35, v67
  s_waitcnt vmcnt(3)
  v_dot2c_f32_bf16 v40, v31, v68
  v_dot2c_f32_bf16 v41, v36, v68
  v_dot2c_f32_bf16 v42, v31, v69
  v_dot2c_f32_bf16 v43, v36, v69
  v_dot2c_f32_bf16 v44, v31, v70
  v_dot2c_f32_bf16 v45, v36, v70
  v_dot2c_f32_bf16 v46, v31, v71
  v_dot2c_f32_bf16 v47, v36, v71
  s_waitcnt vmcnt(2)
  v_dot2c_f32_bf16 v40, v32, v72
  v_dot2c_f32_bf16 v41, v37, v72
  v_dot2c_f32_bf16 v42, v32, v73
  v_dot2c_f32_bf16 v43, v37, v73
  v_dot2c_f32_bf16 v44, v32, v74
  v_dot2c_f32_bf16 v45, v37, v74
  v_dot2c_f32_bf16 v46, v32, v75
  v_dot2c_f32_bf16 v47, v37, v75
  s_waitcnt vmcnt(1)
  v_dot2c_f32_bf16 v40, v33, v76
  v_dot2c_f32_bf16 v41, v38, v76
  v_dot2c_f32_bf16 v42, v33, v77
  v_dot2c_f32_bf16 v43, v38, v77
  v_dot2c_f32_bf16 v44, v33, v78
  v_dot2c_f32_bf16 v45, v38, v78
  v_dot2c_f32_bf16 v46, v33, v79
  v_dot2c_f32_bf16 v47, v38, v79
  s_waitcnt vmcnt(0)
  v_dot2c_f32_bf16 v40, v34, v80
  v_dot2c_f32_bf16 v41, v39, v80
  v_dot2c_f32_bf16 v42, v34, v81
  v_dot2c_f32_bf16 v43, v39, v81
  v_dot2c_f32_bf16 v44, v34, v82
  v_dot2c_f32_bf16 v45, v39, v82
  v_dot2c_f32_bf16 v46, v34, v83
  v_dot2c_f32_bf16 v47, v39, v83
  v_permlane32_swap_b32 v40, v44
  v_permlane32_swap_b32 v41, v45
  v_permlane32_swap_b32 v42, v46
  v_permlane32_swap_b32 v43, v47
  v_add_f32 v40, v40, v44
  v_add_f32 v41, v41, v45
  v_add_f32 v42, v42, v46
  v_add_f32 v43, v43, v47
  s_nop 0
  v_permlane16_swap_b32 v40, v42
  v_permlane16_swap_b32 v41, v43
  v_add_f32 v48, v40, v42
  v_add_f32 v49, v41, v43
  s_nop 0
  v_add_f32_dpp v48, v48, v48 row_ror:8 row_mask:0xf bank_mask:0xf
  v_add_f32_dpp v49, v49, v49 row_ror:8 row_mask:0xf bank_mask:0xf
  v_cndmask_b32 v48, v48, v49, s[62:63]
  ds_write_b32 v12, v48 offset:768
  s_waitcnt lgkmcnt(0)
  s_add_u32 s15, s15, 1
  s_mov_b64 exec, 1
  ds_add_rtn_u32 v13, v14, v15 offset:0
  s_mov_b64 exec, -1
  v_lshrrev_b32 v10, 5, v0
  v_mul_u32_u24 v12, 34816, v10
  v_and_b32 v11, 31, v0
  v_lshl_add_u32 v12, v11, 4, v12
  s_lshl_b32 s12, s4, 4
  s_add_u32 s12, s12, s3
  s_mul_i32 s12, s12, 4352
  v_add_u32 v12, s12, v12
  v_add_u32 v9, 17408, v12
  s_getreg_b32 s13, hwreg(HW_REG_XCC_ID, 0, 4)
  s_lshl_b32 s13, s13, 28
  s_xor_b32 s13, s13, s15
  v_add_u32 v16, 768, v6
  s_mul_i32 s14, s2, 4352
  v_lshlrev_b32 v17, 3, v0
  v_add_u32 v17, s14, v17
  s_waitcnt lgkmcnt(0)
  v_readfirstlane_b32 s12, v13
  s_cmp_lg_u32 s12, 3
  s_cbranch_scc1 L_qnopub
  ds_read2st64_b32 v[18:19], v16 offset0:0 offset1:1
  ds_read2st64_b32 v[20:21], v16 offset0:2 offset1:3
  s_waitcnt lgkmcnt(0)
  v_add_f32 v18, v18, v19
  v_add_f32 v20, v20, v21
  v_add_f32 v18, v18, v20
  v_mov_b32 v19, s13
  global_store_dwordx2 v17, v[18:19], s[38:39]
L_qnopub:
  s_mov_b32 s61, 400000
L_qpoll:
  global_load_dwordx4 v[24:27], v12, s[38:39] sc1
  global_load_dwordx4 v[28:31], v9, s[38:39] sc1
  s_waitcnt vmcnt(0)
  v_xor_b32 v25, s13, v25
  v_xor_b32 v27, s13, v27
  v_xor_b32 v29, s13, v29
  v_xor_b32 v31, s13, v31
  v_or3_b32 v25, v25, v27, v29
  v_or_b32 v25, v25, v31
  v_and_b32 v27, 0x0fffffff, v25
  v_cmp_ne_u32 vcc, 0, v27
  s_cbranch_vccz L_qpolled
  s_sleep 1
  s_cmp_lg_u32 s61, 399988
  s_cbranch_scc1 L_qagain
  s_mov_b32 s60, 4000000
L_lw_41:
  ds_read_b32 v8, v14 offset:0
  s_waitcnt lgkmcnt(0)
  v_cmp_gt_u32 vcc, 4, v8
  s_cbranch_vccz L_lwd_42
  s_sleep 2
  s_sub_u32 s60, s60, 1
  s_cbranch_scc0 L_lw_41
L_lwd_42:
  ds_read2st64_b32 v[18:19], v16 offset0:0 offset1:1
  ds_read2st64_b32 v[20:21], v16 offset0:2 offset1:3
  s_waitcnt lgkmcnt(0)
  v_add_f32 v18, v18, v19
  v_add_f32 v20, v20, v21
  v_add_f32 v18, v18, v20
  v_mov_b32 v19, s13
  global_store_dwordx2 v17, v[18:19], s[38:39] sc1
L_qagain:
  s_sub_u32 s61, s61, 1
  s_cbranch_scc0 L_qpoll
L_qpolled:
  v_cmp_ne_u32 vcc, 0, v25
  s_cbranch_vccz L_qsame
  s_mov_b32 s60, 4000000
L_lw_43:
  ds_read_b32 v8, v14 offset:0
  s_waitcnt lgkmcnt(0)
  v_cmp_gt_u32 vcc, 4, v8
  s_cbranch_vccz L_lwd_44
  s_sleep 2
  s_sub_u32 s60, s60, 1
  s_cbranch_scc0 L_lw_43
L_lwd_44:
  ds_read2st64_b32 v[18:19], v16 offset0:0 offset1:1
  ds_read2st64_b32 v[20:21], v16 offset0:2 offset1:3
  s_waitcnt lgkmcnt(0)
  v_add_f32 v18, v18, v19
  v_add_f32 v20, v20, v21
  v_add_f32 v18, v18, v20
  v_mov_b32 v19, s13
  global_store_dwordx2 v17, v[18:19], s[38:39] sc1
  s_branch L_qdiff
L_qsame:
  s_mov_b64 exec, 1
  ds_add_u32 v14, v15 offset:56
  s_mov_b64 exec, -1
L_qdiff:
  v_add_f32 v24, v24, v28
  v_add_f32 v26, v26, v30
  s_nop 1
  v_permlane32_swap_b32 v24, v26
  v_add_f32 v24, v24, v26
  v_cvt_pk_bf16_f32 v24, v24, v24
  v_lshl_add_u32 v12, v11, 1, v10
  v_lshlrev_b32 v12, 1, v12
  s_lshl_b32 s12, s3, 7
  v_add_u32 v12, s12, v12
  ds_write_b16 v12, v24 offset:256
  s_waitcnt lgkmcnt(0)
  s_mov_b64 exec, 1
  ds_add_u32 v14, v15 offset:4
  s_mov_b64 exec, -1
  s_setprio 1
  s_branch L_down
L_helper2:
  s_setprio 1
  s_cmp_lg_u32 s3, 4
  s_cbranch_scc1 L_noinit
  ds_write_b32 v6, v14
L_noinit:
  s_waitcnt lgkmcnt(0)
  s_add_u32 s74, s38, 1114112
  s_addc_u32 s75, s39, 0
  s_load_dword s15, s[74:75], 0
  s_cmp_lg_u32 s3, 6
  s_cbranch_scc1 L_clrdone
  v_mov_b32 v8, -1
  v_mov_b32 v9, -1
  v_mov_b32 v10, -1
  v_mov_b32 v11, -1
  s_cmp_ge_u32 s67, 160
  s_cbranch_scc1 L_clrffn
  s_mul_i32 s12, s4, 2560
  s_lshl_b32 s13, s6, 8
  s_add_u32 s12, s12, s13
  s_add_u32 s12, s12, 1179648
  v_add_u32 v12, s12, v6
  global_store_dword v12, v8, s[38:39] sc1
  s_branch L_clrdone
L_clrffn:
  s_cmp_ge_u32 s52, 54
  s_cbranch_scc1 L_clrdone
  s_mul_i32 s12, s52, 2560
  s_add_u32 s12, s12, 1245184
  v_add_u32 v12, s12, v1
  global_store_dwordx4 v12, v[8:11], s[38:39] sc1
  global_store_dwordx4 v12, v[8:11], s[38:39] offset:1024 sc1
  s_mov_b32 exec_hi, 0
  global_store_dwordx4 v12, v[8:11], s[38:39] offset:2048 sc1
  s_mov_b64 exec, -1
L_clrdone:
  s_barrier
  s_waitcnt lgkmcnt(0)
  s_add_u32 s15, s15, 1
  s_cmp_eq_u32 s3, 4
  s_cbranch_scc1 L_down
  s_cmp_eq_u32 s3, 5
  s_cbranch_scc1 L_roles
  s_mul_i32 s11, s2, 4352
  v_add_u32 v7, s11, v1
  s_sub_u32 s7, s3, 6
  s_cmp_eq_u32 s7, 0
  s_cbranch_scc1 L_stats
  s_cmp_ge_u32 s52, 54
  s_cbranch_scc1 L_stats
  s_cmp_lt_u32 s53, 4
  s_cselect_b32 s44, s28, s30
  s_cselect_b32 s45, s29, s31
  s_mov_b32 s46, 2211840
  s_mov_b32 s47, 0x20000
  s_and_b32 s50, s3, 3
  s_mul_i32 s50, s50, 552960
  s_lshl_b32 s51, s52, 6
  s_add_u32 s50, s50, s51
  s_add_u32 s81, s50, 6912
  s_add_u32 s82, s50, 13824
  s_add_u32 s83, s50, 20736
  s_add_u32 s84, s50, 27648
  v_lshrrev_b32 v2, 2, v0
  v_mul_u32_u24 v2, 34560, v2
  v_and_b32 v3, 3, v0
  v_lshl_add_u32 v2, v3, 4, v2
  buffer_load_dwordx4 v[64:67], v2, s[44:47], s50 offen offset:0
  buffer_load_dwordx4 v[68:71], v2, s[44:47], s50 offen offset:3456
  s_waitcnt vmcnt(1)
  buffer_load_dwordx4 v[72:75], v2, s[44:47], s81 offen offset:0
  s_waitcnt vmcnt(1)
  buffer_load_dwordx4 v[76:79], v2, s[44:47], s81 offen offset:3456
  s_waitcnt vmcnt(1)
  buffer_load_dwordx4 v[80:83], v2, s[44:47], s82 offen offset:0
  s_waitcnt vmcnt(1)
  buffer_load_dwordx4 v[84:87], v2, s[44:47], s82 offen offset:3456
  s_waitcnt vmcnt(1)
  buffer_load_dwordx4 v[88:91], v2, s[44:47], s83 offen offset:0
  s_waitcnt vmcnt(1)
  buffer_load_dwordx4 v[92:95], v2, s[44:47], s83 offen offset:3456
  s_waitcnt vmcnt(1)
  buffer_load_dwordx4 v[96:99], v2, s[44:47], s84 offen offset:0
  s_waitcnt vmcnt(1)
  buffer_load_dwordx4 v[100:103], v2, s[44:47], s84 offen offset:3456
L_stats:
  s_mov_b32 s60, 4000000
L_lw_45:
  ds_read_b32 v8, v14 offset:4
  s_waitcnt lgkmcnt(0)
  v_cmp_gt_u32 vcc, 4, v8
  s_cbranch_vccz L_lwd_46
  s_sleep 8
  s_sub_u32 s60, s60, 1
  s_cbranch_scc0 L_lw_45
L_lwd_46:
  ds_read_b32 v8, v14 offset:56
  s_waitcnt lgkmcnt(0)
  v_readfirstlane_b32 s66, v8
  s_lshr_b32 s66, s66, 2
  s_cmp_lg_u32 s7, 0
  s_cbranch_scc1 L_noclrO
  v_mov_b32 v8, -1
  v_mov_b32 v9, -1
  v_mov_b32 v10, -1
  v_mov_b32 v11, -1
  s_cmp_eq_u32 s66, 0
  s_cbranch_scc1 L_glob_47
  global_store_dwordx4 v7, v[8:11], s[38:39] offset:1024
  s_branch L_pubd_48
L_glob_47:
  global_store_dwordx4 v7, v[8:11], s[38:39] offset:1024 sc1
L_pubd_48:
L_noclrO:
  s_lshl_b32 s12, s7, 2
  v_mov_b32 v13, s12
  v_and_b32 v20, 3, v0
  v_lshlrev_b32 v20, 8, v20
  v_and_b32 v21, 60, v0
  v_lshl_add_u32 v20, v21, 2, v20
  s_lshl_b32 s12, s7, 14
  s_add_u32 s12, s12, 2048
  v_add_u32 v20, s12, v20
  s_lshl_b32 s12, s7, 13
  s_add_u32 s12, s12, 34816
  v_lshlrev_b32 v21, 3, v0
  v_add_u32 v21, s12, v21
  s_mul_i32 s12, s4, 69632
  s_lshl_b32 s13, s7, 7
  s_add_u32 s12, s12, s13
  v_and_b32 v22, 15, v0
  v_mul_u32_u24 v22, 4352, v22
  v_add_u32 v22, s12, v22
  s_mul_i32 s13, s6, 4352
  s_add_u32 s12, s12, s13
  v_mov_b32 v23, s12
  s_mov_b32 s14, 0x3fb8aa3b
  s_mov_b32 s60, 4000000
L_lw_49:
  ds_read_b32 v8, v13 offset:8
  s_waitcnt lgkmcnt(0)
  v_cmp_gt_u32 vcc, 4, v8
  s_cbranch_vccz L_lwd_50
  s_sleep 4
  s_sub_u32 s60, s60, 1
  s_cbranch_scc0 L_lw_49
L_lwd_50:
  ds_read_b128 v[104:107], v20 offset:0
  ds_read_b128 v[108:111], v20 offset:1024
  ds_read_b128 v[112:115], v20 offset:2048
  ds_read_b128 v[116:119], v20 offset:3072
  ds_read_b128 v[120:123], v20 offset:4096
  ds_read_b128 v[124:127], v20 offset:5120
  ds_read_b128 v[128:131], v20 offset:6144
  ds_read_b128 v[132:135], v20 offset:7168
  s_waitcnt lgkmcnt(7)
  v_add_f32 v104, v104, v105
  v_add_f32 v106, v106, v107
  v_add_f32 v32, v104, v106
  v_cvt_pk_bf16_f32 v32, v32, v32
  v_and_b32 v32, 0xffff0000, v32
  v_mul_f32 v32, 0x3db504f3, v32
  v_cvt_pk_bf16_f32 v32, v32, v32
  v_and_b32 v32, 0xffff0000, v32
  s_waitcnt lgkmcnt(6)
  v_add_f32 v108, v108, v109
  v_add_f32 v110, v110, v111
  v_add_f32 v33, v108, v110
  v_cvt_pk_bf16_f32 v33, v33, v33
  v_and_b32 v33, 0xffff0000, v33
  v_mul_f32 v33, 0x3db504f3, v33
  v_cvt_pk_bf16_f32 v33, v33, v33
  v_and_b32 v33, 0xffff0000, v33
  s_waitcnt lgkmcnt(5)
  v_add_f32 v112, v112, v113
  v_add_f32 v114, v114, v115
  v_add_f32 v34, v112, v114
  v_cvt_pk_bf16_f32 v34, v34, v34
  v_and_b32 v34, 0xffff0000, v34
  v_mul_f32 v34, 0x3db504f3, v34
  v_cvt_pk_bf16_f32 v34, v34, v34
  v_and_b32 v34, 0xffff0000, v34
  s_waitcnt lgkmcnt(4)
  v_add_f32 v116, v116, v117
  v_add_f32 v118, v118, v119
  v_add_f32 v35, v116, v118
  v_cvt_pk_bf16_f32 v35, v35, v35
  v_and_b32 v35, 0xffff0000, v35
  v_mul_f32 v35, 0x3db504f3, v35
  v_cvt_pk_bf16_f32 v35, v35, v35
  v_and_b32 v35, 0xffff0000, v35
  s_waitcnt lgkmcnt(3)
  v_add_f32 v120, v120, v121
  v_add_f32 v122, v122, v123
  v_add_f32 v36, v120, v122
  v_cvt_pk_bf16_f32 v36, v36, v36
  v_and_b32 v36, 0xffff0000, v36
  v_mul_f32 v36, 0x3db504f3, v36
  v_cvt_pk_bf16_f32 v36, v36, v36
  v_and_b32 v36, 0xffff0000, v36
  s_waitcnt lgkmcnt(2)
  v_add_f32 v124, v124, v125
  v_add_f32 v126, v126, v127
  v_add_f32 v37, v124, v126
  v_cvt_pk_bf16_f32 v37, v37, v37
  v_and_b32 v37, 0xffff0000, v37
  v_mul_f32 v37, 0x3db504f3, v37
  v_cvt_pk_bf16_f32 v37, v37, v37
  v_and_b32 v37, 0xffff0000, v37
  s_waitcnt lgkmcnt(1)
  v_add_f32 v128, v128, v129
  v_add_f32 v130, v130, v131
  v_add_f32 v38, v128, v130
  v_cvt_pk_bf16_f32 v38, v38, v38
  v_and_b32 v38, 0xffff0000, v38
  v_mul_f32 v38, 0x3db504f3, v38
  v_cvt_pk_bf16_f32 v38, v38, v38
  v_and_b32 v38, 0xffff0000, v38
  s_waitcnt lgkmcnt(0)
  v_add_f32 v132, v132, v133
  v_add_f32 v134, v134, v135
  v_add_f32 v39, v132, v134
  v_cvt_pk_bf16_f32 v39, v39, v39
  v_and_b32 v39, 0xffff0000, v39
  v_mul_f32 v39, 0x3db504f3, v39
  v_cvt_pk_bf16_f32 v39, v39, v39
  v_and_b32 v39, 0xffff0000, v39
  ds_read_b128 v[104:107], v20 offset:8192
  ds_read_b128 v[108:111], v20 offset:9216
  ds_read_b128 v[112:115], v20 offset:10240
  ds_read_b128 v[116:119], v20 offset:11264
  ds_read_b128 v[120:123], v20 offset:12288
  ds_read_b128 v[124:127], v20 offset:13312
  ds_read_b128 v[128:131], v20 offset:14336
  ds_read_b128 v[132:135], v20 offset:15360
  s_waitcnt lgkmcnt(7)
  v_add_f32 v104, v104, v105
  v_add_f32 v106, v106, v107
  v_add_f32 v40, v104, v106
  v_cvt_pk_bf16_f32 v40, v40, v40
  v_and_b32 v40, 0xffff0000, v40
  v_mul_f32 v40, 0x3db504f3, v40
  v_cvt_pk_bf16_f32 v40, v40, v40
  v_and_b32 v40, 0xffff0000, v40
  s_waitcnt lgkmcnt(6)
  v_add_f32 v108, v108, v109
  v_add_f32 v110, v110, v111
  v_add_f32 v41, v108, v110
  v_cvt_pk_bf16_f32 v41, v41, v41
  v_and_b32 v41, 0xffff0000, v41
  v_mul_f32 v41, 0x3db504f3, v41
  v_cvt_pk_bf16_f32 v41, v41, v41
  v_and_b32 v41, 0xffff0000, v41
  s_waitcnt lgkmcnt(5)
  v_add_f32 v112, v112, v113
  v_add_f32 v114, v114, v115
  v_add_f32 v42, v112, v114
  v_cvt_pk_bf16_f32 v42, v42, v42
  v_and_b32 v42, 0xffff0000, v42
  v_mul_f32 v42, 0x3db504f3, v42
  v_cvt_pk_bf16_f32 v42, v42, v42
  v_and_b32 v42, 0xffff0000, v42
  s_waitcnt lgkmcnt(4)
  v_add_f32 v116, v116, v117
  v_add_f32 v118, v118, v119
  v_add_f32 v43, v116, v118
  v_cvt_pk_bf16_f32 v43, v43, v43
  v_and_b32 v43, 0xffff0000, v43
  v_mul_f32 v43, 0x3db504f3, v43
  v_cvt_pk_bf16_f32 v43, v43, v43
  v_and_b32 v43, 0xffff0000, v43
  s_waitcnt lgkmcnt(3)
  v_add_f32 v120, v120, v121
  v_add_f32 v122, v122, v123
  v_add_f32 v44, v120, v122
  v_cvt_pk_bf16_f32 v44, v44, v44
  v_and_b32 v44, 0xffff0000, v44
  v_mul_f32 v44, 0x3db504f3, v44
  v_cvt_pk_bf16_f32 v44, v44, v44
  v_and_b32 v44, 0xffff0000, v44
  s_waitcnt lgkmcnt(2)
  v_add_f32 v124, v124, v125
  v_add_f32 v126, v126, v127
  v_add_f32 v45, v124, v126
  v_cvt_pk_bf16_f32 v45, v45, v45
  v_and_b32 v45, 0xffff0000, v45
  v_mul_f32 v45, 0x3db504f3, v45
  v_cvt_pk_bf16_f32 v45, v45, v45
  v_and_b32 v45, 0xffff0000, v45
  s_waitcnt lgkmcnt(1)
  v_add_f32 v128, v128, v129
  v_add_f32 v130, v130, v131
  v_add_f32 v46, v128, v130
  v_cvt_pk_bf16_f32 v46, v46, v46
  v_and_b32 v46, 0xffff0000, v46
  v_mul_f32 v46, 0x3db504f3, v46
  v_cvt_pk_bf16_f32 v46, v46, v46
  v_and_b32 v46, 0xffff0000, v46
  s_waitcnt lgkmcnt(0)
  v_add_f32 v132, v132, v133
  v_add_f32 v134, v134, v135
  v_add_f32 v47, v132, v134
  v_cvt_pk_bf16_f32 v47, v47, v47
  v_and_b32 v47, 0xffff0000, v47
  v_mul_f32 v47, 0x3db504f3, v47
  v_cvt_pk_bf16_f32 v47, v47, v47
  v_and_b32 v47, 0xffff0000, v47
  v_max_f32 v28, v32, v33
  v_max3_f32 v28, v28, v34, v35
  v_max3_f32 v28, v28, v36, v37
  v_max3_f32 v28, v28, v38, v39
  v_max3_f32 v28, v28, v40, v41
  v_max3_f32 v28, v28, v42, v43
  v_max3_f32 v28, v28, v44, v45
  v_max3_f32 v28, v28, v46, v47
  s_nop 1
  v_max_f32_dpp v28, v28, v28 row_ror:8 row_mask:0xf bank_mask:0xf
  s_nop 1
  v_max_f32_dpp v28, v28, v28 row_ror:4 row_mask:0xf bank_mask:0xf
  s_nop 1
  v_max_f32_dpp v28, v28, v28 row_ror:2 row_mask:0xf bank_mask:0xf
  s_nop 1
  v_max_f32_dpp v28, v28, v28 row_ror:1 row_mask:0xf bank_mask:0xf
  v_mov_b32 v30, v28
  s_nop 1
  v_permlane16_swap_b32 v28, v30
  v_max_f32 v28, v28, v30
  v_mov_b32 v30, v28
  s_nop 1
  v_permlane32_swap_b32 v28, v30
  v_max_f32 v28, v28, v30
  v_sub_f32 v104, v32, v28
  v_mul_f32 v104, s14, v104
  v_exp_f32 v104, v104
  v_sub_f32 v105, v33, v28
  v_mul_f32 v105, s14, v105
  v_exp_f32 v105, v105
  v_sub_f32 v106, v34, v28
  v_mul_f32 v106, s14, v106
  v_exp_f32 v106, v106
  v_sub_f32 v107, v35, v28
  v_mul_f32 v107, s14, v107
  v_exp_f32 v107, v107
  v_sub_f32 v108, v36, v28
  v_mul_f32 v108, s14, v108
  v_exp_f32 v108, v108
  v_sub_f32 v109, v37, v28
  v_mul_f32 v109, s14, v109
  v_exp_f32 v109, v109
  v_sub_f32 v110, v38, v28
  v_mul_f32 v110, s14, v110
  v_exp_f32 v110, v110
  v_sub_f32 v111, v39, v28
  v_mul_f32 v111, s14, v111
  v_exp_f32 v111, v111
  v_sub_f32 v112, v40, v28
  v_mul_f32 v112, s14, v112
  v_exp_f32 v112, v112
  v_sub_f32 v113, v41, v28
  v_mul_f32 v113, s14, v113
  v_exp_f32 v113, v113
  v_sub_f32 v114, v42, v28
  v_mul_f32 v114, s14, v114
  v_exp_f32 v114, v114
  v_sub_f32 v115, v43, v28
  v_mul_f32 v115, s14, v115
  v_exp_f32 v115, v115
  v_sub_f32 v116, v44, v28
  v_mul_f32 v116, s14, v116
  v_exp_f32 v116, v116
  v_sub_f32 v117, v45, v28
  v_mul_f32 v117, s14, v117
  v_exp_f32 v117, v117
  v_sub_f32 v118, v46, v28
  v_mul_f32 v118, s14, v118
  v_exp_f32 v118, v118
  v_sub_f32 v119, v47, v28
  v_mul_f32 v119, s14, v119
  v_exp_f32 v119, v119
  v_add_f32 v104, v104, v112
  v_add_f32 v105, v105, v113
  v_add_f32 v106, v106, v114
  v_add_f32 v107, v107, v115
  v_add_f32 v108, v108, v116
  v_add_f32 v109, v109, v117
  v_add_f32 v110, v110, v118
  v_add_f32 v111, v111, v119
  v_add_f32 v104, v104, v108
  v_add_f32 v105, v105, v109
  v_add_f32 v106, v106, v110
  v_add_f32 v107, v107, v111
  v_add_f32 v104, v104, v106
  v_add_f32 v105, v105, v107
  v_add_f32 v29, v104, v105
  s_nop 1
  v_add_f32_dpp v29, v29, v29 row_ror:8 row_mask:0xf bank_mask:0xf
  s_nop 1
  v_add_f32_dpp v29, v29, v29 row_ror:4 row_mask:0xf bank_mask:0xf
  s_nop 1
  v_add_f32_dpp v29, v29, v29 row_ror:2 row_mask:0xf bank_mask:0xf
  s_nop 1
  v_add_f32_dpp v29, v29, v29 row_ror:1 row_mask:0xf bank_mask:0xf
  v_mov_b32 v30, v29
  s_nop 1
  v_permlane16_swap_b32 v29, v30
  v_add_f32 v29, v29, v30
  v_mov_b32 v30, v29
  s_nop 1
  v_permlane32_swap_b32 v29, v30
  v_add_f32 v29, v29, v30
  v_mov_b32 v24, v28
  v_mov_b32 v25, s15
  v_mov_b32 v26, v29
  v_mov_b32 v27, s15
  s_waitcnt vmcnt(0)
  s_mov_b64 exec, 1
  s_cmp_eq_u32 s66, 0
  s_cbranch_scc1 L_glob_51
  global_store_dwordx4 v23, v[24:27], s[38:39] offset:512
  s_branch L_pubd_52
L_glob_51:
  global_store_dwordx4 v23, v[24:27], s[38:39] offset:512 sc1
L_pubd_52:
  s_mov_b64 exec, -1
  s_mov_b32 s60, 400000
L_stpoll:
  global_load_dwordx4 v[16:19], v22, s[38:39] offset:512 sc1
  s_waitcnt vmcnt(0)
  v_xor_b32 v17, s15, v17
  v_xor_b32 v19, s15, v19
  v_or_b32 v17, v17, v19
  v_cmp_ne_u32 vcc, 0, v17
  s_cbranch_vccz L_stpolled
  s_sleep 4
  s_sub_u32 s60, s60, 1
  s_cbranch_scc0 L_stpoll
L_stpolled:
  v_mov_b32 v28, v16
  s_nop 1
  v_max_f32_dpp v28, v28, v28 row_ror:8 row_mask:0xf bank_mask:0xf
  s_nop 1
  v_max_f32_dpp v28, v28, v28 row_ror:4 row_mask:0xf bank_mask:0xf
  s_nop 1
  v_max_f32_dpp v28, v28, v28 row_ror:2 row_mask:0xf bank_mask:0xf
  s_nop 1
  v_max_f32_dpp v28, v28, v28 row_ror:1 row_mask:0xf bank_mask:0xf
  v_sub_f32 v24, v16, v28
  v_mul_f32 v24, s14, v24
  v_exp_f32 v24, v24
  s_nop 0
  v_mul_f32 v29, v24, v18
  s_nop 1
  v_add_f32_dpp v29, v29, v29 row_ror:8 row_mask:0xf bank_mask:0xf
  s_nop 1
  v_add_f32_dpp v29, v29, v29 row_ror:4 row_mask:0xf bank_mask:0xf
  s_nop 1
  v_add_f32_dpp v29, v29, v29 row_ror:2 row_mask:0xf bank_mask:0xf
  s_nop 1
  v_add_f32_dpp v29, v29, v29 row_ror:1 row_mask:0xf bank_mask:0xf
  v_rcp_f32 v29, v29
  v_sub_f32 v32, v32, v28
  v_mul_f32 v32, s14, v32
  v_exp_f32 v32, v32
  v_sub_f32 v33, v33, v28
  v_mul_f32 v33, s14, v33
  v_exp_f32 v33, v33
  v_sub_f32 v34, v34, v28
  v_mul_f32 v34, s14, v34
  v_exp_f32 v34, v34
  v_sub_f32 v35, v35, v28
  v_mul_f32 v35, s14, v35
  v_exp_f32 v35, v35
  v_sub_f32 v36, v36, v28
  v_mul_f32 v36, s14, v36
  v_exp_f32 v36, v36
  v_sub_f32 v37, v37, v28
  v_mul_f32 v37, s14, v37
  v_exp_f32 v37, v37
  v_sub_f32 v38, v38, v28
  v_mul_f32 v38, s14, v38
  v_exp_f32 v38, v38
  v_sub_f32 v39, v39, v28
  v_mul_f32 v39, s14, v39
  v_exp_f32 v39, v39
  v_sub_f32 v40, v40, v28
  v_mul_f32 v40, s14, v40
  v_exp_f32 v40, v40
  v_sub_f32 v41, v41, v28
  v_mul_f32 v41, s14, v41
  v_exp_f32 v41, v41
  v_sub_f32 v42, v42, v28
  v_mul_f32 v42, s14, v42
  v_exp_f32 v42, v42
  v_sub_f32 v43, v43, v28
  v_mul_f32 v43, s14, v43
  v_exp_f32 v43, v43
  v_sub_f32 v44, v44, v28
  v_mul_f32 v44, s14, v44
  v_exp_f32 v44, v44
  v_sub_f32 v45, v45, v28
  v_mul_f32 v45, s14, v45
  v_exp_f32 v45, v45
  v_sub_f32 v46, v46, v28
  v_mul_f32 v46, s14, v46
  v_exp_f32 v46, v46
  v_sub_f32 v47, v47, v28
  v_mul_f32 v47, s14, v47
  v_exp_f32 v47, v47
  v_mul_f32 v32, v32, v29
  v_cvt_pk_bf16_f32 v104, v32, 0
  v_cvt_pk_bf16_f32 v105, 0, v32
  ds_write_b64 v21, v[104:105] offset:0
  v_mul_f32 v33, v33, v29
  v_cvt_pk_bf16_f32 v106, v33, 0
  v_cvt_pk_bf16_f32 v107, 0, v33
  ds_write_b64 v21, v[106:107] offset:512
  v_mul_f32 v34, v34, v29
  v_cvt_pk_bf16_f32 v108, v34, 0
  v_cvt_pk_bf16_f32 v109, 0, v34
  ds_write_b64 v21, v[108:109] offset:1024
  v_mul_f32 v35, v35, v29
  v_cvt_pk_bf16_f32 v110, v35, 0
  v_cvt_pk_bf16_f32 v111, 0, v35
  ds_write_b64 v21, v[110:111] offset:1536
  v_mul_f32 v36, v36, v29
  v_cvt_pk_bf16_f32 v112, v36, 0
  v_cvt_pk_bf16_f32 v113, 0, v36
  ds_write_b64 v21, v[112:113] offset:2048
  v_mul_f32 v37, v37, v29
  v_cvt_pk_bf16_f32 v114, v37, 0
  v_cvt_pk_bf16_f32 v115, 0, v37
  ds_write_b64 v21, v[114:115] offset:2560
  v_mul_f32 v38, v38, v29
  v_cvt_pk_bf16_f32 v116, v38, 0
  v_cvt_pk_bf16_f32 v117, 0, v38
  ds_write_b64 v21, v[116:117] offset:3072
  v_mul_f32 v39, v39, v29
  v_cvt_pk_bf16_f32 v118, v39, 0
  v_cvt_pk_bf16_f32 v119, 0, v39
  ds_write_b64 v21, v[118:119] offset:3584
  v_mul_f32 v40, v40, v29
  v_cvt_pk_bf16_f32 v120, v40, 0
  v_cvt_pk_bf16_f32 v121, 0, v40
  ds_write_b64 v21, v[120:121] offset:4096
  v_mul_f32 v41, v41, v29
  v_cvt_pk_bf16_f32 v122, v41, 0
  v_cvt_pk_bf16_f32 v123, 0, v41
  ds_write_b64 v21, v[122:123] offset:4608
  v_mul_f32 v42, v42, v29
  v_cvt_pk_bf16_f32 v124, v42, 0
  v_cvt_pk_bf16_f32 v125, 0, v42
  ds_write_b64 v21, v[124:125] offset:5120
  v_mul_f32 v43, v43, v29
  v_cvt_pk_bf16_f32 v126, v43, 0
  v_cvt_pk_bf16_f32 v127, 0, v43
  ds_write_b64 v21, v[126:127] offset:5632
  v_mul_f32 v44, v44, v29
  v_cvt_pk_bf16_f32 v128, v44, 0
  v_cvt_pk_bf16_f32 v129, 0, v44
  ds_write_b64 v21, v[128:129] offset:6144
  v_mul_f32 v45, v45, v29
  v_cvt_pk_bf16_f32 v130, v45, 0
  v_cvt_pk_bf16_f32 v131, 0, v45
  ds_write_b64 v21, v[130:131] offset:6656
  v_mul_f32 v46, v46, v29
  v_cvt_pk_bf16_f32 v132, v46, 0
  v_cvt_pk_bf16_f32 v133, 0, v46
  ds_write_b64 v21, v[132:133] offset:7168
  v_mul_f32 v47, v47, v29
  v_cvt_pk_bf16_f32 v134, v47, 0
  v_cvt_pk_bf16_f32 v135, 0, v47
  ds_write_b64 v21, v[134:135] offset:7680
  s_waitcnt lgkmcnt(0)
  s_mov_b64 exec, 1
  ds_add_u32 v13, v15 offset:16
  s_mov_b64 exec, -1
  s_cmp_lg_u32 s3, 6
  s_cbranch_scc1 L_h7m
  s_cmp_lg_u32 s6, 0
  s_cbranch_scc1 L_roles
  v_cmp_ne_u32 vcc, 0, v17
  s_cbranch_vccnz L_roles
  v_mov_b32 v12, s15
  s_mov_b64 exec, 1
  global_store_dword v7, v12, s[38:39] offset:768 sc1
  s_mov_b64 exec, -1
  s_branch L_roles
L_h7m:
  s_cmp_ge_u32 s52, 54
  s_cbranch_scc1 L_roles
  v_and_b32 v16, 15, v0
  v_mul_u32_u24 v16, 69632, v16
  s_mov_b32 s60, 400000
L_marks:
  global_load_dword v20, v16, s[38:39] offset:768 sc1
  s_waitcnt vmcnt(0)
  v_xor_b32 v20, s15, v20
  v_cmp_ne_u32 vcc, 0, v20
  s_cbranch_vccz L_marked
  s_sleep 32
  s_sub_u32 s60, s60, 1
  s_cbranch_scc0 L_marks
L_marked:
  s_waitcnt lgkmcnt(0)
  s_mov_b64 exec, 1
  ds_add_u32 v14, v15 offset:52
  s_mov_b64 exec, -1
  s_branch L_roles
L_down:
  s_cmp_ge_u32 s52, 54
  s_cbranch_scc1 L_roles
  s_mov_b32 s44, s32
  s_mov_b32 s45, s33
  s_mov_b32 s46, 2211840
  s_mov_b32 s47, 0x20000
  s_mul_i32 s50, s52, 40960
  s_lshl_b32 s51, s3, 8
  s_add_u32 s50, s50, s51
  v_lshrrev_b32 v2, 4, v0
  v_mul_u32_u24 v2, 10240, v2
  v_and_b32 v3, 15, v0
  v_lshl_add_u32 v2, v3, 4, v2
  buffer_load_dwordx4 v[104:107], v2, s[44:47], s50 offen offset:0 nt
  s_waitcnt vmcnt(0)
  buffer_load_dwordx4 v[108:111], v2, s[44:47], s50 offen offset:1280 nt
  s_waitcnt vmcnt(0)
  buffer_load_dwordx4 v[112:115], v2, s[44:47], s50 offen offset:2560 nt
  s_waitcnt vmcnt(0)
  buffer_load_dwordx4 v[116:119], v2, s[44:47], s50 offen offset:3840 nt
  s_add_u32 s50, s50, 5120
  s_waitcnt vmcnt(0)
  buffer_load_dwordx4 v[120:123], v2, s[44:47], s50 offen offset:0 nt
  s_waitcnt vmcnt(0)
  buffer_load_dwordx4 v[124:127], v2, s[44:47], s50 offen offset:1280 nt
  s_waitcnt vmcnt(0)
  buffer_load_dwordx4 v[128:131], v2, s[44:47], s50 offen offset:2560 nt
  s_waitcnt vmcnt(0)
  buffer_load_dwordx4 v[132:135], v2, s[44:47], s50 offen offset:3840 nt
L_roles:
  s_add_u32 s76, s38, 1179648
  s_addc_u32 s77, s39, 0
  s_add_u32 s78, s38, 1245184
  s_addc_u32 s79, s39, 0
  v_lshlrev_b32 v138, 3, v0
  s_mul_i32 s11, s2, 4352
  v_add_u32 v139, s11, v138
  s_waitcnt vmcnt(0)
  s_mov_b64 exec, 0
  s_cmp_lt_u32 s67, 160
  s_cbranch_scc1 L_wo_go
  s_cmp_lt_u32 s52, 54
  s_cbranch_scc1 L_ffn_go
  s_branch L_none_go
L_warmed:
  s_mov_b64 exec, -1
  s_cmp_lg_u32 s3, 5
  s_cbranch_scc1 L_nogov
  s_mov_b32 s60, 4000000
L_lw_53:
  ds_read_b32 v8, v14 offset:4
  s_waitcnt lgkmcnt(0)
  v_cmp_gt_u32 vcc, 4, v8
  s_cbranch_vccz L_lwd_54
  s_sleep 8
  s_sub_u32 s60, s60, 1
  s_cbranch_scc0 L_lw_53
L_lwd_54:
  ds_read_b32 v8, v14 offset:56
  s_waitcnt lgkmcnt(0)
  v_readfirstlane_b32 s12, v8
  s_cmp_lg_u32 s12, 4
  s_cbranch_scc1 L_nogov
  s_lshr_b32 s12, s2, 5
  s_lshl_b32 s12, s12, 8
  s_add_u32 s12, s12, 1146880
  v_and_b32 v16, 31, v0
  v_lshlrev_b32 v16, 2, v16
  v_add_u32 v16, s12, v16
  s_and_b32 s64, s2, 31
  s_lshl_b32 s13, s64, 2
  s_add_u32 s12, s12, s13
  v_mov_b32 v17, s12
  s_lshl_b32 s13, s15, 10
  s_cmp_lt_u32 s52, 54
  s_cselect_b32 s65, 0, 8
  s_add_u32 s65, s65, s13
  s_mov_b32 s61, 4000
L_gov:
  ds_read_b32 v20, v14 offset:44
  s_waitcnt lgkmcnt(0)
  v_add_u32 v19, s65, v20
  s_mov_b64 exec, 1
  global_store_dword v17, v19, s[38:39]
  s_mov_b64 exec, -1
  global_load_dword v18, v16, s[38:39] sc1
  v_readfirstlane_b32 s62, v20
  s_waitcnt vmcnt(0)
  s_cmp_ge_u32 s62, 212
  s_cbranch_scc1 L_nogov
  v_subrev_u32 v18, s13, v18
  v_cmp_le_u32 vcc, 0x400, v18
  s_cbranch_vccnz L_gov_next
  v_readlane_b32 s62, v18, s64
  v_add_u32_dpp v18, v18, v18 row_ror:8 row_mask:0xf bank_mask:0xf
  s_nop 1
  v_add_u32_dpp v18, v18, v18 row_ror:4 row_mask:0xf bank_mask:0xf
  s_nop 1
  v_add_u32_dpp v18, v18, v18 row_ror:2 row_mask:0xf bank_mask:0xf
  s_nop 1
  v_add_u32_dpp v18, v18, v18 row_ror:1 row_mask:0xf bank_mask:0xf
  s_lshl_b32 s62, s62, 5
  v_readlane_b32 s63, v18, 0
  v_readlane_b32 s12, v18, 16
  s_add_u32 s63, s63, s12
  s_sub_i32 s62, s62, s63
  s_mov_b32 s63, 2
  s_cmp_gt_i32 s62, 96
  s_cselect_b32 s63, 1, s63
  s_cmp_lt_i32 s62, -64
  s_cselect_b32 s63, 3, s63
  v_mov_b32 v18, s63
  ds_write_b32 v14, v18 offset:28
L_gov_next:
  s_sleep 2
  s_sub_u32 s61, s61, 1
  s_cbranch_scc0 L_gov
L_nogov:
  s_cmp_lg_u32 s3, 7
  s_cbranch_scc1 L_noA
  s_mov_b32 s60, 4000000
L_lw_55:
  ds_read_b32 v8, v14 offset:24
  s_waitcnt lgkmcnt(0)
  v_cmp_gt_u32 vcc, 4, v8
  s_cbranch_vccz L_lwd_56
  s_sleep 8
  s_sub_u32 s60, s60, 1
  s_cbranch_scc0 L_lw_55
L_lwd_56:
  ds_read_b64 v[142:143], v138 offset:51200
  ds_read_b64 v[144:145], v138 offset:51712
  ds_read_b64 v[146:147], v138 offset:52224
  ds_read_b64 v[148:149], v138 offset:52736
  s_waitcnt lgkmcnt(0)
  v_pk_add_f32 v[142:143], v[142:143], v[144:145]
  v_pk_add_f32 v[146:147], v[146:147], v[148:149]
  v_pk_add_f32 v[140:141], v[142:143], v[146:147]
  v_min_u32 v140, -2, v140
  v_min_u32 v141, -2, v141
  s_cmp_eq_u32 s66, 0
  s_cbranch_scc1 L_noAloc
  global_store_dwordx2 v139, v[140:141], s[38:39] offset:1024
L_noAloc:
  s_setprio 3
L_noA:
  s_cmp_lt_u32 s67, 160
  s_cbranch_scc1 L_wo
  s_cmp_lt_u32 s52, 54
  s_cbranch_scc1 L_ffn
L_none_go:
  s_cmp_lg_u32 s3, 7
  s_cbranch_scc1 L_tend
  s_cbranch_execz L_live_57
  s_mov_b32 s60, 4000000
L_lw_58:
  ds_read_b32 v150, v14 offset:44
  s_waitcnt lgkmcnt(0)
  v_cmp_gt_u32 vcc, 216, v150
  s_cbranch_vccz L_lwd_59
  s_sleep 24
  s_sub_u32 s60, s60, 1
  s_cbranch_scc0 L_lw_58
L_lwd_59:
L_live_57:
  s_cbranch_execz L_live_60
  s_mov_b32 s60, 4000000
L_lw_61:
  ds_read_b32 v150, v14 offset:48
  s_waitcnt lgkmcnt(0)
  v_cmp_gt_u32 vcc, 4, v150
  s_cbranch_vccz L_lwd_62
  s_sleep 1
  s_sub_u32 s60, s60, 1
  s_cbranch_scc0 L_lw_61
L_lwd_62:
L_live_60:
  ds_read_b64 v[142:143], v138 offset:53248
  ds_read_b64 v[144:145], v138 offset:53760
  ds_read_b64 v[146:147], v138 offset:54272
  ds_read_b64 v[148:149], v138 offset:54784
  s_waitcnt lgkmcnt(0)
  v_pk_add_f32 v[142:143], v[142:143], v[144:145]
  v_pk_add_f32 v[146:147], v[146:147], v[148:149]
  v_pk_add_f32 v[142:143], v[142:143], v[146:147]
  v_min_u32 v142, -2, v142
  v_min_u32 v143, -2, v143
  s_cbranch_execz L_live_63
  s_cmp_eq_u32 s66, 0
  s_cbranch_scc1 L_oglob_64
  global_store_dwordx2 v139, v[142:143], s[38:39] offset:1536
  s_branch L_odone_65
L_oglob_64:
  global_store_dwordx2 v139, v[142:143], s[38:39] offset:1536 sc1
  global_store_dwordx2 v139, v[140:141], s[38:39] offset:1024 sc1
L_odone_65:
  v_mov_b32 v150, 1
  ds_write_b32 v14, v150 offset:60
  s_setprio 1
L_live_63:
  s_branch L_tend
L_wo:
  s_mul_i32 s12, s4, 69632
  s_lshl_b32 s13, s3, 7
  s_add_u32 s12, s12, s13
  v_and_b32 v3, 7, v0
  v_mul_u32_u24 v2, 8704, v3
  v_lshrrev_b32 v4, 3, v0
  v_lshl_add_u32 v2, v4, 4, v2
  v_add_u32 v2, s12, v2
  v_add_u32 v8, 4352, v2
  v_lshrrev_b32 v5, 4, v0
  v_lshlrev_b32 v5, 3, v5
  v_lshl_add_u32 v5, v3, 5, v5
  s_lshl_b32 s13, s3, 8
  v_add_u32 v5, s13, v5
  s_mul_i32 s12, s4, 2560
  s_lshl_b32 s13, s6, 8
  s_add_u32 s12, s12, s13
  v_add_u32 v7, s12, v6
  v_add_u32 v6, 55296, v6
  v_mov_b32 v40, 0
  v_mov_b32 v41, 0
  v_mov_b32 v42, 0
  v_mov_b32 v43, 0
  v_mov_b32 v44, 0
  v_mov_b32 v45, 0
  v_mov_b32 v46, 0
  v_mov_b32 v47, 0
  s_mov_b32 s44, s24
  s_mov_b32 s45, s25
  s_mov_b32 s46, 5242880
  s_mov_b32 s47, 0x20000
  s_lshr_b32 s50, s4, 1
  s_and_b32 s51, s50, 4
  s_add_u32 s50, s50, s51
  s_and_b32 s51, s4, 1
  s_lshl_b32 s51, s51, 2
  s_or_b32 s50, s50, s51
  s_lshl_b32 s50, s50, 2
  s_and_b32 s51, s3, 3
  s_add_u32 s50, s50, s51
  s_and_b32 s51, s3, 4
  s_lshl_b32 s51, s51, 4
  s_add_u32 s50, s50, s51
  s_mul_i32 s50, s50, 40960
  s_lshl_b32 s51, s6, 7
  s_add_u32 s50, s50, s51
  v_mul_u32_u24 v9, 5120, v4
  v_lshl_add_u32 v9, v3, 4, v9
  s_cmp_ge_u32 s3, 4
  s_cbranch_scc1 L_nopreA
  s_mov_b32 s60, 4000000
L_lw_66:
  ds_read_b32 v150, v14 offset:44
  s_waitcnt lgkmcnt(0)
  v_cmp_gt_u32 vcc, 188, v150
  s_cbranch_vccz L_lwd_67
  s_sleep 24
  s_sub_u32 s60, s60, 1
  s_cbranch_scc0 L_lw_66
L_lwd_67:
  global_load_dwordx4 v[24:27], v2, s[38:39] offset:1024 sc1
  s_waitcnt vmcnt(0)
  global_load_dwordx4 v[28:31], v8, s[38:39] offset:1024 sc1
  s_waitcnt vmcnt(0)
L_nopreA:
  s_mov_b32 s60, 4000000
L_lw_68:
  ds_read_b32 v150, v14 offset:44
  s_waitcnt lgkmcnt(0)
  v_cmp_gt_u32 vcc, 220, v150
  s_cbranch_vccz L_lwd_69
  s_sleep 24
  s_sub_u32 s60, s60, 1
  s_cbranch_scc0 L_lw_68
L_lwd_69:
L_wo_go:
  s_cbranch_execz L_live_70
  s_mov_b32 s60, 4000000
L_lw_71:
  ds_read_b32 v150, v14 offset:44
  s_waitcnt lgkmcnt(0)
  v_cmp_gt_u32 vcc, 232, v150
  s_cbranch_vccz L_lwd_72
  s_sleep 2
  s_sub_u32 s60, s60, 1
  s_cbranch_scc0 L_lw_71
L_lwd_72:
  buffer_load_dwordx4 v[64:67], v9, s[44:47], s50 offen offset:0 nt
  buffer_load_dwordx4 v[68:71], v9, s[44:47], s50 offen offset:1280 nt
  buffer_load_dwordx4 v[72:75], v9, s[44:47], s50 offen offset:2560 nt
  buffer_load_dwordx4 v[76:79], v9, s[44:47], s50 offen offset:3840 nt
L_live_70:
  s_cmp_lg_u32 s3, 7
  s_cbranch_scc1 L_wo_np
  s_cbranch_execz L_live_73
  s_mov_b32 s60, 4000000
L_lw_74:
  ds_read_b32 v150, v14 offset:48
  s_waitcnt lgkmcnt(0)
  v_cmp_gt_u32 vcc, 4, v150
  s_cbranch_vccz L_lwd_75
  s_sleep 1
  s_sub_u32 s60, s60, 1
  s_cbranch_scc0 L_lw_74
L_lwd_75:
L_live_73:
  ds_read_b64 v[142:143], v138 offset:53248
  ds_read_b64 v[144:145], v138 offset:53760
  ds_read_b64 v[146:147], v138 offset:54272
  ds_read_b64 v[148:149], v138 offset:54784
  s_waitcnt lgkmcnt(0)
  v_pk_add_f32 v[142:143], v[142:143], v[144:145]
  v_pk_add_f32 v[146:147], v[146:147], v[148:149]
  v_pk_add_f32 v[142:143], v[142:143], v[146:147]
  v_min_u32 v142, -2, v142
  v_min_u32 v143, -2, v143
  s_cbranch_execz L_live_76
  s_cmp_eq_u32 s66, 0
  s_cbranch_scc1 L_oglob_77
  global_store_dwordx2 v139, v[142:143], s[38:39] offset:1536
  s_branch L_odone_78
L_oglob_77:
  global_store_dwordx2 v139, v[142:143], s[38:39] offset:1536 sc1
  global_store_dwordx2 v139, v[140:141], s[38:39] offset:1024 sc1
L_odone_78:
  v_mov_b32 v150, 1
  ds_write_b32 v14, v150 offset:60
  s_setprio 1
L_live_76:
  s_branch L_wo_p
L_wo_np:
  s_cbranch_execz L_live_79
  s_mov_b32 s60, 4000000
L_lw_80:
  ds_read_b32 v150, v14 offset:60
  s_waitcnt lgkmcnt(0)
  v_cmp_gt_u32 vcc, 1, v150
  s_cbranch_vccz L_lwd_81
  s_sleep 1
  s_sub_u32 s60, s60, 1
  s_cbranch_scc0 L_lw_80
L_lwd_81:
L_live_79:
L_wo_p:
  s_cmp_lt_u32 s3, 4
  s_cbranch_scc1 L_wo_a
  s_cbranch_execz L_live_82
  global_load_dwordx4 v[24:27], v2, s[38:39] offset:1024 sc1
  global_load_dwordx4 v[28:31], v8, s[38:39] offset:1024 sc1
L_live_82:
  s_waitcnt vmcnt(2)
  s_branch L_wo_b
L_wo_a:
  s_waitcnt vmcnt(0)
L_wo_b:
  v_perm_b32 v136, v68, v64, s70
  v_perm_b32 v68, v68, v64, s71
  v_perm_b32 v64, v69, v65, s70
  v_perm_b32 v69, v69, v65, s71
  v_perm_b32 v65, v70, v66, s70
  v_perm_b32 v70, v70, v66, s71
  v_perm_b32 v66, v71, v67, s70
  v_perm_b32 v71, v71, v67, s71
  v_perm_b32 v67, v76, v72, s70
  v_perm_b32 v76, v76, v72, s71
  v_perm_b32 v72, v77, v73, s70
  v_perm_b32 v77, v77, v73, s71
  v_perm_b32 v73, v78, v74, s70
  v_perm_b32 v78, v78, v74, s71
  v_perm_b32 v74, v79, v75, s70
  v_perm_b32 v79, v79, v75, s71
  s_cbranch_execz L_live_83
  s_mov_b32 s60, 400000
L_spoll_84:
  s_waitcnt vmcnt(0)
  v_add_f32 v16, v24, v28
  v_add_f32 v17, v25, v29
  v_add_f32 v18, v26, v30
  v_add_f32 v19, v27, v31
  v_max3_u32 v14, v16, v17, v18
  v_max_u32 v14, v14, v19
  v_cmp_eq_u32 vcc, -1, v14
  s_cbranch_vccz L_spolled_85
  v_max3_u32 v14, v24, v25, v26
  v_max_u32 v14, v14, v27
  v_cmp_eq_u32 vcc, -1, v14
  s_cbranch_vccz L_gsk_86
  s_mov_b64 exec, vcc
  global_load_dwordx4 v[24:27], v2, s[38:39] offset:1024 sc1
  s_mov_b64 exec, -1
L_gsk_86:
  v_max3_u32 v14, v28, v29, v30
  v_max_u32 v14, v14, v31
  v_cmp_eq_u32 vcc, -1, v14
  s_cbranch_vccz L_gsk_87
  s_mov_b64 exec, vcc
  global_load_dwordx4 v[28:31], v8, s[38:39] offset:1024 sc1
  s_mov_b64 exec, -1
L_gsk_87:
  s_sub_u32 s60, s60, 1
  s_cbranch_scc0 L_spoll_84
  s_waitcnt vmcnt(0)
L_spolled_85:
L_live_83:
  v_add_f32_dpp v16, v16, v16 quad_perm:[1,0,3,2] row_mask:0xf bank_mask:0xf
  v_add_f32_dpp v17, v17, v17 quad_perm:[1,0,3,2] row_mask:0xf bank_mask:0xf
  v_add_f32_dpp v18, v18, v18 quad_perm:[1,0,3,2] row_mask:0xf bank_mask:0xf
  v_add_f32_dpp v19, v19, v19 quad_perm:[1,0,3,2] row_mask:0xf bank_mask:0xf
  v_add_f32_dpp v16, v16, v16 quad_perm:[2,3,0,1] row_mask:0xf bank_mask:0xf
  v_add_f32_dpp v17, v17, v17 quad_perm:[2,3,0,1] row_mask:0xf bank_mask:0xf
  v_add_f32_dpp v18, v18, v18 quad_perm:[2,3,0,1] row_mask:0xf bank_mask:0xf
  v_add_f32_dpp v19, v19, v19 quad_perm:[2,3,0,1] row_mask:0xf bank_mask:0xf
  v_add_f32_dpp v16, v16, v16 row_half_mirror row_mask:0xf bank_mask:0xf
  v_add_f32_dpp v17, v17, v17 row_half_mirror row_mask:0xf bank_mask:0xf
  v_add_f32_dpp v18, v18, v18 row_half_mirror row_mask:0xf bank_mask:0xf
  v_add_f32_dpp v19, v19, v19 row_half_mirror row_mask:0xf bank_mask:0xf
  v_cvt_pk_bf16_f32 v32, v16, v17
  v_cvt_pk_bf16_f32 v33, v18, v19
  v_dot2c_f32_bf16 v40, v32, v136
  v_dot2c_f32_bf16 v41, v32, v68
  v_dot2c_f32_bf16 v42, v32, v64
  v_dot2c_f32_bf16 v43, v32, v69
  v_dot2c_f32_bf16 v44, v32, v65
  v_dot2c_f32_bf16 v45, v32, v70
  v_dot2c_f32_bf16 v46, v32, v66
  v_dot2c_f32_bf16 v47, v32, v71
  v_dot2c_f32_bf16 v40, v33, v67
  v_dot2c_f32_bf16 v41, v33, v76
  v_dot2c_f32_bf16 v42, v33, v72
  v_dot2c_f32_bf16 v43, v33, v77
  v_dot2c_f32_bf16 v44, v33, v73
  v_dot2c_f32_bf16 v45, v33, v78
  v_dot2c_f32_bf16 v46, v33, v74
  v_dot2c_f32_bf16 v47, v33, v79
  v_permlane32_swap_b32 v40, v44
  v_permlane32_swap_b32 v41, v45
  v_permlane32_swap_b32 v42, v46
  v_permlane32_swap_b32 v43, v47
  v_add_f32 v40, v40, v44
  v_add_f32 v41, v41, v45
  v_add_f32 v42, v42, v46
  v_add_f32 v43, v43, v47
  s_nop 0
  v_permlane16_swap_b32 v40, v42
  v_permlane16_swap_b32 v41, v43
  v_add_f32 v48, v40, v42
  v_add_f32 v49, v41, v43
  s_nop 0
  v_add_f32_dpp v48, v48, v48 row_ror:8 row_mask:0xf bank_mask:0xf
  v_add_f32_dpp v49, v49, v49 row_ror:8 row_mask:0xf bank_mask:0xf
  ds_write_b64 v5, v[48:49] offset:55296
  s_waitcnt lgkmcnt(0)
  s_cbranch_execz L_live_88
  s_barrier
L_live_88:
  s_cmp_lg_u32 s3, 0
  s_cbranch_scc1 L_tend
  ds_read2st64_b32 v[16:17], v6 offset0:0 offset1:1
  ds_read2st64_b32 v[18:19], v6 offset0:2 offset1:3
  ds_read2st64_b32 v[20:21], v6 offset0:4 offset1:5
  ds_read2st64_b32 v[22:23], v6 offset0:6 offset1:7
  s_waitcnt lgkmcnt(0)
  v_pk_add_f32 v[16:17], v[16:17], v[18:19]
  v_pk_add_f32 v[20:21], v[20:21], v[22:23]
  v_pk_add_f32 v[16:17], v[16:17], v[20:21]
  v_add_f32 v16, v16, v17
  v_min_u32 v16, -2, v16
  s_cbranch_execz L_live_89
  global_store_dword v7, v16, s[76:77] sc1
L_live_89:
  s_branch L_tend
L_ffn:
  v_lshrrev_b32 v2, 4, v0
  v_and_b32 v3, 15, v0
  s_min_u32 s12, s3, 4
  s_lshl_b32 s12, s12, 8
  v_lshrrev_b32 v5, 1, v2
  v_lshlrev_b32 v5, 7, v5
  v_lshl_add_u32 v5, v3, 3, v5
  v_and_b32 v4, 1, v2
  v_lshl_add_u32 v5, v4, 2, v5
  v_add_u32 v5, s12, v5
  global_load_dword v11, v5, s[16:17]
  s_lshl_b32 s12, s3, 9
  v_mul_u32_u24 v4, 10240, v2
  v_lshl_add_u32 v4, v3, 4, v4
  v_add_u32 v4, s12, v4
  v_add_u32 v62, 5120, v4
  v_mov_b32 v63, 0
  v_mov_b32 v6, 0x3f803f80
  v_lshrrev_b32 v7, 2, v0
  v_mul_u32_u24 v7, 20, v7
  s_and_b32 s13, s3, 3
  s_mul_i32 s13, s13, 320
  s_add_u32 s13, s13, 57344
  v_add_u32 v7, s13, v7
  v_and_b32 v8, 3, v0
  v_lshlrev_b32 v8, 5, v8
  v_lshl_add_u32 v8, v2, 3, v8
  s_lshl_b32 s13, s53, 7
  v_add_u32 v8, s13, v8
  v_and_b32 v9, 7, v0
  v_lshl_add_u32 v9, v2, 3, v9
  v_lshlrev_b32 v9, 2, v9
  v_add_u32 v9, 59904, v9
  s_mul_i32 s13, s52, 2560
  s_add_u32 s13, s13, s12
  v_lshlrev_b32 v10, 3, v0
  v_add_u32 v10, s13, v10
  v_add_u32 v3, 2112, v9
  v_mov_b32 v52, 0
  v_mov_b32 v53, 0
  v_mov_b32 v54, 0
  v_mov_b32 v55, 0
  v_mov_b32 v56, 0
  v_mov_b32 v57, 0
  v_mov_b32 v58, 0
  v_mov_b32 v59, 0
  s_mov_b32 s14, 0x3fb8aa3b
  v_perm_b32 v137, v108, v104, s70
  v_perm_b32 v108, v108, v104, s71
  v_perm_b32 v104, v109, v105, s70
  v_perm_b32 v109, v109, v105, s71
  v_perm_b32 v105, v110, v106, s70
  v_perm_b32 v110, v110, v106, s71
  v_perm_b32 v106, v111, v107, s70
  v_perm_b32 v111, v111, v107, s71
  v_perm_b32 v107, v116, v112, s70
  v_perm_b32 v116, v116, v112, s71
  v_perm_b32 v112, v117, v113, s70
  v_perm_b32 v117, v117, v113, s71
  v_perm_b32 v113, v118, v114, s70
  v_perm_b32 v118, v118, v114, s71
  v_perm_b32 v114, v119, v115, s70
  v_perm_b32 v119, v119, v115, s71
  v_perm_b32 v115, v124, v120, s70
  v_perm_b32 v124, v124, v120, s71
  v_perm_b32 v120, v125, v121, s70
  v_perm_b32 v125, v125, v121, s71
  v_perm_b32 v121, v126, v122, s70
  v_perm_b32 v126, v126, v122, s71
  v_perm_b32 v122, v127, v123, s70
  v_perm_b32 v127, v127, v123, s71
  v_perm_b32 v123, v132, v128, s70
  v_perm_b32 v132, v132, v128, s71
  v_perm_b32 v128, v133, v129, s70
  v_perm_b32 v133, v133, v129, s71
  v_perm_b32 v129, v134, v130, s70
  v_perm_b32 v134, v134, v130, s71
  v_perm_b32 v130, v135, v131, s70
  v_perm_b32 v135, v135, v131, s71
  s_cmp_lt_u32 s53, 4
  s_cselect_b32 s44, s28, s30
  s_cselect_b32 s45, s29, s31
  s_mov_b32 s46, 2211840
  s_mov_b32 s47, 0x20000
  s_and_b32 s50, s3, 3
  s_mul_i32 s50, s50, 552960
  s_lshl_b32 s51, s52, 6
  s_add_u32 s50, s50, s51
  s_add_u32 s81, s50, 6912
  s_add_u32 s82, s50, 13824
  s_add_u32 s83, s50, 20736
  s_add_u32 s84, s50, 27648
  v_lshrrev_b32 v15, 2, v0
  v_mul_u32_u24 v15, 34560, v15
  v_and_b32 v1, 3, v0
  v_lshl_add_u32 v15, v1, 4, v15
  s_mov_b32 s60, 4000000
L_lw_90:
  ds_read_b32 v150, v14 offset:52
  s_waitcnt lgkmcnt(0)
  v_cmp_gt_u32 vcc, 1, v150
  s_cbranch_vccz L_lwd_91
  s_sleep 8
  s_sub_u32 s60, s60, 1
  s_cbranch_scc0 L_lw_90
L_lwd_91:
  s_waitcnt vmcnt(0)
  v_and_b32 v13, 0xffff0000, v11
  v_lshlrev_b32 v12, 16, v11
  s_mov_b32 s60, 4000000
L_lw_92:
  ds_read_b32 v150, v14 offset:44
  s_waitcnt lgkmcnt(0)
  v_cmp_gt_u32 vcc, 216, v150
  s_cbranch_vccz L_lwd_93
  s_sleep 24
  s_sub_u32 s60, s60, 1
  s_cbranch_scc0 L_lw_92
L_lwd_93:
L_ffn_go:
  s_cmp_eq_u32 s3, 7
  s_cbranch_scc1 L_ffn_pub
  s_cbranch_execz L_live_94
  s_mov_b32 s60, 4000000
L_lw_95:
  ds_read_b32 v150, v14 offset:44
  s_waitcnt lgkmcnt(0)
  v_cmp_gt_u32 vcc, 236, v150
  s_cbranch_vccz L_lwd_96
  s_sleep 2
  s_sub_u32 s60, s60, 1
  s_cbranch_scc0 L_lw_95
L_lwd_96:
L_live_94:
  s_cbranch_execz L_live_97
  buffer_load_dwordx4 v[64:67], v15, s[44:47], s50 offen offset:0
  buffer_load_dwordx4 v[68:71], v15, s[44:47], s50 offen offset:3456
  buffer_load_dwordx4 v[72:75], v15, s[44:47], s81 offen offset:0
  buffer_load_dwordx4 v[76:79], v15, s[44:47], s81 offen offset:3456
L_live_97:
  s_cbranch_execz L_live_98
  buffer_load_dwordx4 v[80:83], v15, s[44:47], s82 offen offset:0
  buffer_load_dwordx4 v[84:87], v15, s[44:47], s82 offen offset:3456
  buffer_load_dwordx4 v[88:91], v15, s[44:47], s83 offen offset:0
  buffer_load_dwordx4 v[92:95], v15, s[44:47], s83 offen offset:3456
L_live_98:
  s_cbranch_execz L_live_99
  buffer_load_dwordx4 v[96:99], v15, s[44:47], s84 offen offset:0
  buffer_load_dwordx4 v[100:103], v15, s[44:47], s84 offen offset:3456
L_live_99:
  s_branch L_ffn_w0
L_ffn_pub:
  s_cbranch_execz L_live_100
  s_mov_b32 s60, 4000000
L_lw_101:
  ds_read_b32 v150, v14 offset:48
  s_waitcnt lgkmcnt(0)
  v_cmp_gt_u32 vcc, 4, v150
  s_cbranch_vccz L_lwd_102
  s_sleep 1
  s_sub_u32 s60, s60, 1
  s_cbranch_scc0 L_lw_101
L_lwd_102:
L_live_100:
  ds_read_b64 v[142:143], v138 offset:53248
  ds_read_b64 v[144:145], v138 offset:53760
  ds_read_b64 v[146:147], v138 offset:54272
  ds_read_b64 v[148:149], v138 offset:54784
  s_waitcnt lgkmcnt(0)
  v_pk_add_f32 v[142:143], v[142:143], v[144:145]
  v_pk_add_f32 v[146:147], v[146:147], v[148:149]
  v_pk_add_f32 v[142:143], v[142:143], v[146:147]
  v_min_u32 v142, -2, v142
  v_min_u32 v143, -2, v143
  s_cbranch_execz L_live_103
  s_cmp_eq_u32 s66, 0
  s_cbranch_scc1 L_oglob_104
  global_store_dwordx2 v139, v[142:143], s[38:39] offset:1536
  s_branch L_odone_105
L_oglob_104:
  global_store_dwordx2 v139, v[142:143], s[38:39] offset:1536 sc1
  global_store_dwordx2 v139, v[140:141], s[38:39] offset:1024 sc1
L_odone_105:
  v_mov_b32 v150, 1
  ds_write_b32 v14, v150 offset:60
  s_setprio 1
L_live_103:
L_ffn_w0:
L_ffn_have:
  s_waitcnt vmcnt(8)
  v_perm_b32 v136, v68, v64, s70
  v_perm_b32 v68, v68, v64, s71
  v_perm_b32 v64, v69, v65, s70
  v_perm_b32 v69, v69, v65, s71
  v_perm_b32 v65, v70, v66, s70
  v_perm_b32 v70, v70, v66, s71
  v_perm_b32 v66, v71, v67, s70
  v_perm_b32 v71, v71, v67, s71
  v_dot2_f32_bf16 v40, v6, v136, 0
  v_dot2_f32_bf16 v41, v6, v68, 0
  v_dot2_f32_bf16 v42, v6, v64, 0
  v_dot2_f32_bf16 v43, v6, v69, 0
  v_dot2_f32_bf16 v44, v6, v65, 0
  v_dot2_f32_bf16 v45, v6, v70, 0
  v_dot2_f32_bf16 v46, v6, v66, 0
  v_dot2_f32_bf16 v47, v6, v71, 0
  s_waitcnt vmcnt(6)
  v_perm_b32 v67, v76, v72, s70
  v_perm_b32 v76, v76, v72, s71
  v_perm_b32 v72, v77, v73, s70
  v_perm_b32 v77, v77, v73, s71
  v_perm_b32 v73, v78, v74, s70
  v_perm_b32 v78, v78, v74, s71
  v_perm_b32 v74, v79, v75, s70
  v_perm_b32 v79, v79, v75, s71
  v_dot2c_f32_bf16 v40, v6, v67
  v_dot2c_f32_bf16 v41, v6, v76
  v_dot2c_f32_bf16 v42, v6, v72
  v_dot2c_f32_bf16 v43, v6, v77
  v_dot2c_f32_bf16 v44, v6, v73
  v_dot2c_f32_bf16 v45, v6, v78
  v_dot2c_f32_bf16 v46, v6, v74
  v_dot2c_f32_bf16 v47, v6, v79
  s_waitcnt vmcnt(4)
  v_perm_b32 v75, v84, v80, s70
  v_perm_b32 v84, v84, v80, s71
  v_perm_b32 v80, v85, v81, s70
  v_perm_b32 v85, v85, v81, s71
  v_perm_b32 v81, v86, v82, s70
  v_perm_b32 v86, v86, v82, s71
  v_perm_b32 v82, v87, v83, s70
  v_perm_b32 v87, v87, v83, s71
  v_dot2c_f32_bf16 v40, v6, v75
  v_dot2c_f32_bf16 v41, v6, v84
  v_dot2c_f32_bf16 v42, v6, v80
  v_dot2c_f32_bf16 v43, v6, v85
  v_dot2c_f32_bf16 v44, v6, v81
  v_dot2c_f32_bf16 v45, v6, v86
  v_dot2c_f32_bf16 v46, v6, v82
  v_dot2c_f32_bf16 v47, v6, v87
  s_waitcnt vmcnt(2)
  v_perm_b32 v83, v92, v88, s70
  v_perm_b32 v92, v92, v88, s71
  v_perm_b32 v88, v93, v89, s70
  v_perm_b32 v93, v93, v89, s71
  v_perm_b32 v89, v94, v90, s70
  v_perm_b32 v94, v94, v90, s71
  v_perm_b32 v90, v95, v91, s70
  v_perm_b32 v95, v95, v91, s71
  v_dot2c_f32_bf16 v40, v6, v83
  v_dot2c_f32_bf16 v41, v6, v92
  v_dot2c_f32_bf16 v42, v6, v88
  v_dot2c_f32_bf16 v43, v6, v93
  v_dot2c_f32_bf16 v44, v6, v89
  v_dot2c_f32_bf16 v45, v6, v94
  v_dot2c_f32_bf16 v46, v6, v90
  v_dot2c_f32_bf16 v47, v6, v95
  s_waitcnt vmcnt(0)
  s_cmp_ge_u32 s3, 5
  s_cbranch_scc1 L_nopoll
  s_cbranch_execz L_live_106
  global_load_dwordx4 v[140:143], v4, s[76:77] offset:0 sc1
  global_load_dwordx4 v[144:147], v4, s[76:77] offset:256 sc1
  global_load_dwordx4 v[148:151], v4, s[76:77] offset:2560 sc1
  global_load_dwordx4 v[152:155], v4, s[76:77] offset:2816 sc1
  global_load_dwordx4 v[156:159], v62, s[76:77] offset:0 sc1
  global_load_dwordx4 v[160:163], v62, s[76:77] offset:256 sc1
  global_load_dwordx4 v[24:27], v62, s[76:77] offset:2560 sc1
  global_load_dwordx4 v[28:31], v62, s[76:77] offset:2816 sc1
L_live_106:
L_nopoll:
  v_perm_b32 v91, v100, v96, s70
  v_perm_b32 v100, v100, v96, s71
  v_perm_b32 v96, v101, v97, s70
  v_perm_b32 v101, v101, v97, s71
  v_perm_b32 v97, v102, v98, s70
  v_perm_b32 v102, v102, v98, s71
  v_perm_b32 v98, v103, v99, s70
  v_perm_b32 v103, v103, v99, s71
  v_dot2c_f32_bf16 v40, v6, v91
  v_dot2c_f32_bf16 v41, v6, v100
  v_dot2c_f32_bf16 v42, v6, v96
  v_dot2c_f32_bf16 v43, v6, v101
  v_dot2c_f32_bf16 v44, v6, v97
  v_dot2c_f32_bf16 v45, v6, v102
  v_dot2c_f32_bf16 v46, v6, v98
  v_dot2c_f32_bf16 v47, v6, v103
  v_permlane32_swap_b32 v40, v44
  v_permlane32_swap_b32 v41, v45
  v_permlane32_swap_b32 v42, v46
  v_permlane32_swap_b32 v43, v47
  v_add_f32 v40, v40, v44
  v_add_f32 v41, v41, v45
  v_add_f32 v42, v42, v46
  v_add_f32 v43, v43, v47
  s_nop 0
  v_permlane16_swap_b32 v40, v42
  v_permlane16_swap_b32 v41, v43
  v_add_f32 v48, v40, v42
  v_add_f32 v49, v41, v43
  s_nop 0
  v_add_f32_dpp v48, v48, v48 row_ror:8 row_mask:0xf bank_mask:0xf
  v_add_f32_dpp v49, v49, v49 row_ror:8 row_mask:0xf bank_mask:0xf
  s_nop 0
  v_add_f32_dpp v48, v48, v48 row_ror:4 row_mask:0xf bank_mask:0xf
  v_add_f32_dpp v49, v49, v49 row_ror:4 row_mask:0xf bank_mask:0xf
  ds_write_b64 v8, v[48:49] offset:60992
  s_waitcnt lgkmcnt(0)
  s_cmp_ge_u32 s3, 5
  s_cbranch_scc1 L_h_wait
  s_cbranch_execz L_live_107
  s_mov_b32 s60, 400000
L_spoll_108:
  s_waitcnt vmcnt(0)
  v_pk_add_f32 v[16:17], v[140:141], v[148:149]
  v_pk_add_f32 v[32:33], v[156:157], v[24:25]
  v_pk_add_f32 v[18:19], v[142:143], v[150:151]
  v_pk_add_f32 v[34:35], v[158:159], v[26:27]
  v_pk_add_f32 v[20:21], v[144:145], v[152:153]
  v_pk_add_f32 v[36:37], v[160:161], v[28:29]
  v_pk_add_f32 v[22:23], v[146:147], v[154:155]
  v_pk_add_f32 v[38:39], v[162:163], v[30:31]
  v_pk_add_f32 v[16:17], v[16:17], v[32:33]
  v_pk_add_f32 v[18:19], v[18:19], v[34:35]
  v_pk_add_f32 v[20:21], v[20:21], v[36:37]
  v_pk_add_f32 v[22:23], v[22:23], v[38:39]
  v_max3_u32 v14, v16, v17, v18
  v_max3_u32 v14, v14, v19, v20
  v_max3_u32 v14, v14, v21, v22
  v_max_u32 v14, v14, v23
  v_cmp_eq_u32 vcc, -1, v14
  s_cbranch_vccz L_spolled_109
  v_max3_u32 v14, v140, v141, v142
  v_max3_u32 v14, v14, v143, v144
  v_max3_u32 v14, v14, v145, v146
  v_max_u32 v14, v14, v147
  v_cmp_eq_u32 vcc, -1, v14
  s_cbranch_vccz L_gsk_110
  s_mov_b64 exec, vcc
  global_load_dwordx4 v[140:143], v4, s[76:77] offset:0 sc1
  global_load_dwordx4 v[144:147], v4, s[76:77] offset:256 sc1
  s_mov_b64 exec, -1
L_gsk_110:
  v_max3_u32 v14, v148, v149, v150
  v_max3_u32 v14, v14, v151, v152
  v_max3_u32 v14, v14, v153, v154
  v_max_u32 v14, v14, v155
  v_cmp_eq_u32 vcc, -1, v14
  s_cbranch_vccz L_gsk_111
  s_mov_b64 exec, vcc
  global_load_dwordx4 v[148:151], v4, s[76:77] offset:2560 sc1
  global_load_dwordx4 v[152:155], v4, s[76:77] offset:2816 sc1
  s_mov_b64 exec, -1
L_gsk_111:
  v_max3_u32 v14, v156, v157, v158
  v_max3_u32 v14, v14, v159, v160
  v_max3_u32 v14, v14, v161, v162
  v_max_u32 v14, v14, v163
  v_cmp_eq_u32 vcc, -1, v14
  s_cbranch_vccz L_gsk_112
  s_mov_b64 exec, vcc
  global_load_dwordx4 v[156:159], v62, s[76:77] offset:0 sc1
  global_load_dwordx4 v[160:163], v62, s[76:77] offset:256 sc1
  s_mov_b64 exec, -1
L_gsk_112:
  v_max3_u32 v14, v24, v25, v26
  v_max3_u32 v14, v14, v27, v28
  v_max3_u32 v14, v14, v29, v30
  v_max_u32 v14, v14, v31
  v_cmp_eq_u32 vcc, -1, v14
  s_cbranch_vccz L_gsk_113
  s_mov_b64 exec, vcc
  global_load_dwordx4 v[24:27], v62, s[76:77] offset:2560 sc1
  global_load_dwordx4 v[28:31], v62, s[76:77] offset:2816 sc1
  s_mov_b64 exec, -1
L_gsk_113:
  s_sub_u32 s60, s60, 1
  s_cbranch_scc0 L_spoll_108
  s_waitcnt vmcnt(0)
L_spolled_109:
L_live_107:
  v_permlane32_swap_b32 v16, v20
  v_permlane32_swap_b32 v17, v21
  v_permlane32_swap_b32 v18, v22
  v_permlane32_swap_b32 v19, v23
  v_add_f32 v16, v16, v20
  v_add_f32 v17, v17, v21
  v_add_f32 v18, v18, v22
  v_add_f32 v19, v19, v23
  s_nop 0
  v_permlane16_swap_b32 v16, v18
  v_permlane16_swap_b32 v17, v19
  v_add_f32 v32, v16, v18
  v_add_f32 v33, v17, v19
  v_cvt_pk_bf16_f32 v34, v32, v33
  v_lshlrev_b32 v32, 16, v34
  v_and_b32 v33, 0xffff0000, v34
  v_pk_add_f32 v[32:33], v[32:33], v[12:13]
  v_cvt_pk_bf16_f32 v34, v32, v33
  ds_write_b32 v5, v34 offset:57344
  s_waitcnt lgkmcnt(0)
L_h_wait:
  s_cbranch_execz L_live_114
  s_barrier
L_live_114:
  ds_read2_b32 v[16:17], v7 offset0:0 offset1:1
  ds_read2_b32 v[18:19], v7 offset0:2 offset1:3
  ds_read_b32 v20, v7 offset:16
  s_waitcnt lgkmcnt(0)
  v_dot2_f32_bf16 v40, v16, v136, 0
  v_dot2_f32_bf16 v41, v16, v68, 0
  v_dot2_f32_bf16 v42, v16, v64, 0
  v_dot2_f32_bf16 v43, v16, v69, 0
  v_dot2_f32_bf16 v44, v16, v65, 0
  v_dot2_f32_bf16 v45, v16, v70, 0
  v_dot2_f32_bf16 v46, v16, v66, 0
  v_dot2_f32_bf16 v47, v16, v71, 0
  v_dot2c_f32_bf16 v40, v17, v67
  v_dot2c_f32_bf16 v41, v17, v76
  v_dot2c_f32_bf16 v42, v17, v72
  v_dot2c_f32_bf16 v43, v17, v77
  v_dot2c_f32_bf16 v44, v17, v73
  v_dot2c_f32_bf16 v45, v17, v78
  v_dot2c_f32_bf16 v46, v17, v74
  v_dot2c_f32_bf16 v47, v17, v79
  v_dot2c_f32_bf16 v40, v18, v75
  v_dot2c_f32_bf16 v41, v18, v84
  v_dot2c_f32_bf16 v42, v18, v80
  v_dot2c_f32_bf16 v43, v18, v85
  v_dot2c_f32_bf16 v44, v18, v81
  v_dot2c_f32_bf16 v45, v18, v86
  v_dot2c_f32_bf16 v46, v18, v82
  v_dot2c_f32_bf16 v47, v18, v87
  v_dot2c_f32_bf16 v40, v19, v83
  v_dot2c_f32_bf16 v41, v19, v92
  v_dot2c_f32_bf16 v42, v19, v88
  v_dot2c_f32_bf16 v43, v19, v93
  v_dot2c_f32_bf16 v44, v19, v89
  v_dot2c_f32_bf16 v45, v19, v94
  v_dot2c_f32_bf16 v46, v19, v90
  v_dot2c_f32_bf16 v47, v19, v95
  v_dot2c_f32_bf16 v40, v20, v91
  v_dot2c_f32_bf16 v41, v20, v100
  v_dot2c_f32_bf16 v42, v20, v96
  v_dot2c_f32_bf16 v43, v20, v101
  v_dot2c_f32_bf16 v44, v20, v97
  v_dot2c_f32_bf16 v45, v20, v102
  v_dot2c_f32_bf16 v46, v20, v98
  v_dot2c_f32_bf16 v47, v20, v103
  v_permlane32_swap_b32 v40, v44
  v_permlane32_swap_b32 v41, v45
  v_permlane32_swap_b32 v42, v46
  v_permlane32_swap_b32 v43, v47
  v_add_f32 v40, v40, v44
  v_add_f32 v41, v41, v45
  v_add_f32 v42, v42, v46
  v_add_f32 v43, v43, v47
  s_nop 0
  v_permlane16_swap_b32 v40, v42
  v_permlane16_swap_b32 v41, v43
  v_add_f32 v48, v40, v42
  v_add_f32 v49, v41, v43
  s_nop 0
  v_add_f32_dpp v48, v48, v48 row_ror:8 row_mask:0xf bank_mask:0xf
  v_add_f32_dpp v49, v49, v49 row_ror:8 row_mask:0xf bank_mask:0xf
  s_nop 0
  v_add_f32_dpp v48, v48, v48 row_ror:4 row_mask:0xf bank_mask:0xf
  v_add_f32_dpp v49, v49, v49 row_ror:4 row_mask:0xf bank_mask:0xf
  ds_write_b64 v8, v[48:49] offset:59904
  s_waitcnt lgkmcnt(0)
  s_cbranch_execz L_live_115
  s_barrier
L_live_115:
  s_cmp_ge_u32 s3, 5
  s_cbranch_scc1 L_final
  ds_read2_b32 v[16:17], v9 offset0:0 offset1:128
  ds_read2_b32 v[18:19], v9 offset0:32 offset1:160
  ds_read2_b32 v[20:21], v9 offset0:64 offset1:192
  ds_read2_b32 v[22:23], v9 offset0:96 offset1:224
  ds_read2_b32 v[32:33], v3 offset0:0 offset1:32
  ds_read_b32 v34, v63 offset:62272
  s_waitcnt lgkmcnt(0)
  v_pk_add_f32 v[16:17], v[16:17], v[18:19]
  v_pk_add_f32 v[20:21], v[20:21], v[22:23]
  v_pk_add_f32 v[16:17], v[16:17], v[32:33] neg_lo:[0,1] neg_hi:[0,1]
  v_pk_add_f32 v[16:17], v[16:17], v[20:21]
  v_pk_mul_f32 v[16:17], v[16:17], v[34:35] op_sel_hi:[1,0]
  v_cvt_pk_bf16_f32 v20, v16, v17
  v_lshlrev_b32 v16, 16, v20
  v_mul_f32 v17, s14, v16
  v_exp_f32 v17, -v17
  v_and_b32 v20, 0xffff0000, v20
  v_add_f32 v17, 1.0, v17
  v_rcp_f32 v17, v17
  s_nop 0
  v_mul_f32 v16, v16, v17
  v_cvt_pk_bf16_f32 v16, v16, v16
  v_and_b32 v16, 0xffff0000, v16
  v_mul_f32 v16, v16, v20
  s_nop 1
  v_mov_b32_dpp v17, v16 quad_perm:[1,0,3,2] row_mask:0xf bank_mask:0xf
  v_cvt_pk_bf16_f32 v16, v16, v17
  s_nop 1
  v_dot2c_f32_bf16_dpp v52, v16, v137 row_newbcast:0 row_mask:0xf bank_mask:0xf
  v_dot2c_f32_bf16_dpp v53, v16, v108 row_newbcast:0 row_mask:0xf bank_mask:0xf
  v_dot2c_f32_bf16_dpp v54, v16, v104 row_newbcast:0 row_mask:0xf bank_mask:0xf
  v_dot2c_f32_bf16_dpp v55, v16, v109 row_newbcast:0 row_mask:0xf bank_mask:0xf
  v_dot2c_f32_bf16_dpp v56, v16, v105 row_newbcast:0 row_mask:0xf bank_mask:0xf
  v_dot2c_f32_bf16_dpp v57, v16, v110 row_newbcast:0 row_mask:0xf bank_mask:0xf
  v_dot2c_f32_bf16_dpp v58, v16, v106 row_newbcast:0 row_mask:0xf bank_mask:0xf
  v_dot2c_f32_bf16_dpp v59, v16, v111 row_newbcast:0 row_mask:0xf bank_mask:0xf
  v_dot2c_f32_bf16_dpp v52, v16, v107 row_newbcast:2 row_mask:0xf bank_mask:0xf
  v_dot2c_f32_bf16_dpp v53, v16, v116 row_newbcast:2 row_mask:0xf bank_mask:0xf
  v_dot2c_f32_bf16_dpp v54, v16, v112 row_newbcast:2 row_mask:0xf bank_mask:0xf
  v_dot2c_f32_bf16_dpp v55, v16, v117 row_newbcast:2 row_mask:0xf bank_mask:0xf
  v_dot2c_f32_bf16_dpp v56, v16, v113 row_newbcast:2 row_mask:0xf bank_mask:0xf
  v_dot2c_f32_bf16_dpp v57, v16, v118 row_newbcast:2 row_mask:0xf bank_mask:0xf
  v_dot2c_f32_bf16_dpp v58, v16, v114 row_newbcast:2 row_mask:0xf bank_mask:0xf
  v_dot2c_f32_bf16_dpp v59, v16, v119 row_newbcast:2 row_mask:0xf bank_mask:0xf
  v_dot2c_f32_bf16_dpp v52, v16, v115 row_newbcast:4 row_mask:0xf bank_mask:0xf
  v_dot2c_f32_bf16_dpp v53, v16, v124 row_newbcast:4 row_mask:0xf bank_mask:0xf
  v_dot2c_f32_bf16_dpp v54, v16, v120 row_newbcast:4 row_mask:0xf bank_mask:0xf
  v_dot2c_f32_bf16_dpp v55, v16, v125 row_newbcast:4 row_mask:0xf bank_mask:0xf
  v_dot2c_f32_bf16_dpp v56, v16, v121 row_newbcast:4 row_mask:0xf bank_mask:0xf
  v_dot2c_f32_bf16_dpp v57, v16, v126 row_newbcast:4 row_mask:0xf bank_mask:0xf
  v_dot2c_f32_bf16_dpp v58, v16, v122 row_newbcast:4 row_mask:0xf bank_mask:0xf
  v_dot2c_f32_bf16_dpp v59, v16, v127 row_newbcast:4 row_mask:0xf bank_mask:0xf
  v_dot2c_f32_bf16_dpp v52, v16, v123 row_newbcast:6 row_mask:0xf bank_mask:0xf
  v_dot2c_f32_bf16_dpp v53, v16, v132 row_newbcast:6 row_mask:0xf bank_mask:0xf
  v_dot2c_f32_bf16_dpp v54, v16, v128 row_newbcast:6 row_mask:0xf bank_mask:0xf
  v_dot2c_f32_bf16_dpp v55, v16, v133 row_newbcast:6 row_mask:0xf bank_mask:0xf
  v_dot2c_f32_bf16_dpp v56, v16, v129 row_newbcast:6 row_mask:0xf bank_mask:0xf
  v_dot2c_f32_bf16_dpp v57, v16, v134 row_newbcast:6 row_mask:0xf bank_mask:0xf
  v_dot2c_f32_bf16_dpp v58, v16, v130 row_newbcast:6 row_mask:0xf bank_mask:0xf
  v_dot2c_f32_bf16_dpp v59, v16, v135 row_newbcast:6 row_mask:0xf bank_mask:0xf
  v_permlane32_swap_b32 v52, v56
  v_permlane32_swap_b32 v53, v57
  v_permlane32_swap_b32 v54, v58
  v_permlane32_swap_b32 v55, v59
  v_add_f32 v52, v52, v56
  v_add_f32 v53, v53, v57
  v_add_f32 v54, v54, v58
  v_add_f32 v55, v55, v59
  s_nop 0
  v_permlane16_swap_b32 v52, v54
  v_permlane16_swap_b32 v53, v55
  v_add_f32 v60, v52, v54
  v_add_f32 v61, v53, v55
  v_min_u32 v60, -2, v60
  v_min_u32 v61, -2, v61
  s_cbranch_execz L_live_116
  global_store_dwordx2 v10, v[60:61], s[78:79] sc1
  v_mov_b32 v16, 1
  s_waitcnt vmcnt(0)
  ds_write_b32 v63, v16 offset:64
L_live_116:
  s_branch L_tend
L_final:
  s_cmp_lg_u32 s3, 6
  s_cbranch_scc1 L_final5
  s_cbranch_execz L_lnstat
  s_branch L_fin
L_lnstat:
  v_lshlrev_b32 v24, 2, v0
  v_add_u32 v25, 57344, v24
  v_lshrrev_b32 v26, 5, v0
  v_mul_u32_u24 v26, 384, v26
  v_add_u32 v26, v26, v24
  v_add_u32 v26, 60992, v26
  s_cbranch_execz L_live_117
  s_setprio 1
  s_barrier
L_live_117:
  ds_read2st64_b32 v[16:17], v25 offset0:0 offset1:1
  ds_read2st64_b32 v[18:19], v25 offset0:2 offset1:3
  ds_read_b32 v20, v25 offset:1024
  ds_read2_b32 v[28:29], v26 offset0:0 offset1:32
  ds_read2_b32 v[30:31], v26 offset0:64 offset1:96
  s_waitcnt lgkmcnt(2)
  v_readfirstlane_b32 s12, v16
  v_lshlrev_b32 v40, 16, v16
  v_and_b32 v41, 0xffff0000, v16
  v_lshlrev_b32 v42, 16, v17
  v_and_b32 v43, 0xffff0000, v17
  v_lshlrev_b32 v44, 16, v18
  v_and_b32 v45, 0xffff0000, v18
  v_lshlrev_b32 v46, 16, v19
  v_and_b32 v47, 0xffff0000, v19
  v_lshlrev_b32 v48, 16, v20
  v_and_b32 v49, 0xffff0000, v20
  s_lshl_b32 s12, s12, 16
  s_mov_b32 s13, s12
  v_pk_add_f32 v[40:41], v[40:41], s[12:13] neg_lo:[0,1] neg_hi:[0,1]
  v_pk_add_f32 v[42:43], v[42:43], s[12:13] neg_lo:[0,1] neg_hi:[0,1]
  v_pk_add_f32 v[44:45], v[44:45], s[12:13] neg_lo:[0,1] neg_hi:[0,1]
  v_pk_add_f32 v[46:47], v[46:47], s[12:13] neg_lo:[0,1] neg_hi:[0,1]
  v_pk_add_f32 v[48:49], v[48:49], s[12:13] neg_lo:[0,1] neg_hi:[0,1]
  v_pk_add_f32 v[32:33], v[40:41], v[42:43]
  v_pk_mul_f32 v[34:35], v[40:41], v[40:41]
  v_pk_add_f32 v[36:37], v[44:45], v[46:47]
  v_pk_fma_f32 v[34:35], v[42:43], v[42:43], v[34:35]
  v_pk_add_f32 v[32:33], v[32:33], v[48:49]
  v_pk_fma_f32 v[34:35], v[44:45], v[44:45], v[34:35]
  v_pk_add_f32 v[32:33], v[32:33], v[36:37]
  v_pk_fma_f32 v[34:35], v[46:47], v[46:47], v[34:35]
  v_add_f32 v36, v32, v33
  v_pk_fma_f32 v[34:35], v[48:49], v[48:49], v[34:35]
  s_waitcnt lgkmcnt(0)
  v_pk_add_f32 v[28:29], v[28:29], v[30:31]
  v_add_f32 v37, v34, v35
  v_add_f32 v28, v28, v29
  v_add_f32_dpp v36, v36, v36 row_ror:8 row_mask:0xf bank_mask:0xf
  v_add_f32_dpp v37, v37, v37 row_ror:8 row_mask:0xf bank_mask:0xf
  s_nop 0
  v_add_f32_dpp v36, v36, v36 row_ror:4 row_mask:0xf bank_mask:0xf
  v_add_f32_dpp v37, v37, v37 row_ror:4 row_mask:0xf bank_mask:0xf
  s_nop 0
  v_add_f32_dpp v36, v36, v36 row_ror:2 row_mask:0xf bank_mask:0xf
  v_add_f32_dpp v37, v37, v37 row_ror:2 row_mask:0xf bank_mask:0xf
  s_nop 0
  v_add_f32_dpp v36, v36, v36 row_ror:1 row_mask:0xf bank_mask:0xf
  v_add_f32_dpp v37, v37, v37 row_ror:1 row_mask:0xf bank_mask:0xf
  s_nop 1
  v_permlane16_swap_b32 v36, v37
  v_add_f32 v36, v36, v37
  v_mov_b32 v37, v36
  s_nop 1
  v_permlane32_swap_b32 v36, v37
  v_add_f32 v36, v36, v37
  v_mov_b32 v37, v36
  s_nop 1
  v_permlane16_swap_b32 v36, v37
  v_mul_f32 v38, 0x3acccccd, v36
  v_fma_f32 v39, -v38, v36, v37
  v_add_f32 v38, s12, v38
  v_mul_f32 v39, 0x3acccccd, v39
  v_cvt_pk_bf16_f32 v39, v38, v39
  v_lshlrev_b32 v38, 16, v39
  v_and_b32 v39, 0xffff0000, v39
  v_mul_f32 v28, v28, v38
  v_add_f32 v39, 0x3727c5ac, v39
  ds_write_b32 v24, v28 offset:62016
  v_cvt_pk_bf16_f32 v39, v39, v39
  v_and_b32 v39, 0xffff0000, v39
  v_sqrt_f32 v39, v39
  v_mov_b32 v27, 0
  v_cvt_pk_bf16_f32 v39, v39, v39
  v_and_b32 v39, 0xffff0000, v39
  v_rcp_f32 v39, v39
  s_nop 0
  ds_write_b32 v27, v39 offset:62272
  s_waitcnt lgkmcnt(0)
  s_cbranch_execz L_live_118
  s_barrier
L_live_118:
  s_branch L_tend
L_final5:
  s_cmp_lg_u32 s3, 5
  s_cbranch_scc1 L_tend
  s_cmp_ge_u32 s52, 20
  s_cbranch_scc1 L_tend
  s_mov_b32 s44, s78
  s_mov_b32 s45, s79
  s_mov_b32 s46, 138240
  s_mov_b32 s47, 0x20000
  v_lshrrev_b32 v4, 3, v0
  v_mul_u32_u24 v4, 2560, v4
  v_and_b32 v5, 7, v0
  v_lshl_add_u32 v4, v5, 4, v4
  s_lshl_b32 s12, s52, 7
  v_add_u32 v4, s12, v4
  v_lshl_add_u32 v5, v5, 2, v2
  v_and_b32 v6, 1, v5
  v_lshrrev_b32 v5, 1, v5
  v_lshl_add_u32 v5, v5, 3, v6
  s_lshr_b32 s12, s52, 2
  s_lshl_b32 s12, s12, 7
  s_and_b32 s13, s52, 3
  s_lshl_b32 s13, s13, 1
  s_add_u32 s12, s12, s13
  v_add_u32 v5, s12, v5
  v_lshlrev_b32 v6, 2, v5
  v_lshlrev_b32 v5, 1, v5
  ds_read_u16 v7, v5 offset:57344
  s_mov_b32 s81, 20480
  s_mov_b32 s82, 40960
  s_mov_b32 s83, 61440
  s_mov_b32 s84, 81920
  s_mov_b32 s85, 102400
  s_mov_b32 s86, 122880
  s_mov_b32 s12, 0x00ff00ff
  s_mov_b32 s13, 0x00ff00ff
  s_waitcnt lgkmcnt(0)
  v_lshlrev_b32 v7, 16, v7
  s_cbranch_execz L_live_119
  s_mov_b32 s60, 4000000
L_lw_120:
  ds_read_b32 v150, v63 offset:64
  s_waitcnt lgkmcnt(0)
  v_cmp_gt_u32 vcc, 1, v150
  s_cbranch_vccz L_lwd_121
  s_sub_u32 s60, s60, 1
  s_cbranch_scc0 L_lw_120
L_lwd_121:
  s_mov_b32 s60, 400000
  buffer_load_dwordx4 v[104:107], v4, s[44:47], 0 offen sc1
  buffer_load_dwordx4 v[108:111], v4, s[44:47], s81 offen sc1
  buffer_load_dwordx4 v[112:115], v4, s[44:47], s82 offen sc1
  buffer_load_dwordx4 v[116:119], v4, s[44:47], s83 offen sc1
  buffer_load_dwordx4 v[120:123], v4, s[44:47], s84 offen sc1
  buffer_load_dwordx4 v[124:127], v4, s[44:47], s85 offen sc1
  buffer_load_dwordx4 v[128:131], v4, s[44:47], s86 offen sc1
L_spoll_122:
  s_waitcnt vmcnt(0)
  v_pk_add_f32 v[16:17], v[104:105], v[108:109]
  v_pk_add_f32 v[20:21], v[112:113], v[116:117]
  v_pk_add_f32 v[24:25], v[120:121], v[124:125]
  v_pk_add_f32 v[18:19], v[106:107], v[110:111]
  v_pk_add_f32 v[22:23], v[114:115], v[118:119]
  v_pk_add_f32 v[26:27], v[122:123], v[126:127]
  v_pk_add_f32 v[16:17], v[16:17], v[20:21]
  v_pk_add_f32 v[24:25], v[24:25], v[128:129]
  v_pk_add_f32 v[18:19], v[18:19], v[22:23]
  v_pk_add_f32 v[26:27], v[26:27], v[130:131]
  v_pk_add_f32 v[16:17], v[16:17], v[24:25]
  v_pk_add_f32 v[18:19], v[18:19], v[26:27]
  v_max3_u32 v14, v16, v17, v18
  v_max_u32 v14, v14, v19
  v_cmp_eq_u32 vcc, -1, v14
  s_cbranch_vccz L_spolled_123
  v_max3_u32 v14, v104, v105, v106
  v_max_u32 v14, v14, v107
  v_cmp_eq_u32 vcc, -1, v14
  s_cbranch_vccz L_gsk_124
  s_mov_b64 exec, vcc
  buffer_load_dwordx4 v[104:107], v4, s[44:47], 0 offen sc1
  s_mov_b64 exec, -1
L_gsk_124:
  v_max3_u32 v14, v108, v109, v110
  v_max_u32 v14, v14, v111
  v_cmp_eq_u32 vcc, -1, v14
  s_cbranch_vccz L_gsk_125
  s_mov_b64 exec, vcc
  buffer_load_dwordx4 v[108:111], v4, s[44:47], s81 offen sc1
  s_mov_b64 exec, -1
L_gsk_125:
  v_max3_u32 v14, v112, v113, v114
  v_max_u32 v14, v14, v115
  v_cmp_eq_u32 vcc, -1, v14
  s_cbranch_vccz L_gsk_126
  s_mov_b64 exec, vcc
  buffer_load_dwordx4 v[112:115], v4, s[44:47], s82 offen sc1
  s_mov_b64 exec, -1
L_gsk_126:
  v_max3_u32 v14, v116, v117, v118
  v_max_u32 v14, v14, v119
  v_cmp_eq_u32 vcc, -1, v14
  s_cbranch_vccz L_gsk_127
  s_mov_b64 exec, vcc
  buffer_load_dwordx4 v[116:119], v4, s[44:47], s83 offen sc1
  s_mov_b64 exec, -1
L_gsk_127:
  v_max3_u32 v14, v120, v121, v122
  v_max_u32 v14, v14, v123
  v_cmp_eq_u32 vcc, -1, v14
  s_cbranch_vccz L_gsk_128
  s_mov_b64 exec, vcc
  buffer_load_dwordx4 v[120:123], v4, s[44:47], s84 offen sc1
  s_mov_b64 exec, -1
L_gsk_128:
  v_max3_u32 v14, v124, v125, v126
  v_max_u32 v14, v14, v127
  v_cmp_eq_u32 vcc, -1, v14
  s_cbranch_vccz L_gsk_129
  s_mov_b64 exec, vcc
  buffer_load_dwordx4 v[124:127], v4, s[44:47], s85 offen sc1
  s_mov_b64 exec, -1
L_gsk_129:
  v_max3_u32 v14, v128, v129, v130
  v_max_u32 v14, v14, v131
  v_cmp_eq_u32 vcc, -1, v14
  s_cbranch_vccz L_gsk_130
  s_mov_b64 exec, vcc
  buffer_load_dwordx4 v[128:131], v4, s[44:47], s86 offen sc1
  s_mov_b64 exec, -1
L_gsk_130:
  s_sub_u32 s60, s60, 1
  s_cbranch_scc0 L_spoll_122
  s_waitcnt vmcnt(0)
L_spolled_123:
L_live_119:
  v_permlane32_swap_b32 v16, v18
  v_permlane32_swap_b32 v17, v19
  v_add_f32 v16, v16, v18
  v_add_f32 v17, v17, v19
  s_nop 1
  v_permlane16_swap_b32 v16, v17
  v_add_f32 v20, v16, v17
  s_nop 1
  v_add_f32_dpp v20, v20, v20 row_ror:8 row_mask:0xf bank_mask:0xf
  v_cvt_pk_bf16_f32 v20, v20, v20
  v_and_b32 v20, 0xffff0000, v20
  v_add_f32 v20, v20, v7
  v_cvt_pk_bf16_f32 v20, v20, v20
  s_cbranch_execz L_warmed
  s_mov_b64 exec, s[12:13]
  global_store_short v5, v20, s[34:35]
  s_cmp_lg_u32 s52, 0
  s_cbranch_scc1 L_noep
  s_mov_b64 exec, 1
  v_mov_b32 v5, 0x110000
  v_mov_b32 v6, s15
  global_store_dword v5, v6, s[38:39]
L_noep:
  s_mov_b64 exec, -1
L_tend:
  s_cbranch_execz L_warmed
L_fin:
L_exit:
  s_endpgm
.section .rodata,"a"
.p2align 6
.amdhsa_kernel sequential_preLN__mha_block_cached__swiglu_ffn__decode_kernel
  .amdhsa_next_free_vgpr 168
  .amdhsa_next_free_sgpr 96
  .amdhsa_accum_offset 168
  .amdhsa_group_segment_fixed_size 0
  .amdhsa_kernarg_size 96
  .amdhsa_user_sgpr_count 2
  .amdhsa_user_sgpr_kernarg_segment_ptr 1
  .amdhsa_system_sgpr_workgroup_id_x 1
  .amdhsa_float_denorm_mode_32 3
.end_amdhsa_kernel
```
